```python
import torch

def _softmax(x, axis=-1):
    return torch.softmax(x, dim=axis)
def _gelu(x):
    return torch.nn.functional.gelu(x, approximate="tanh")
def _silu(x):
    return torch.nn.functional.silu(x)
def _sigmoid(x):
    return torch.sigmoid(x)
def _layernorm(x, axis=-1, eps=1e-5):
    m = x.mean(dim=axis, keepdim=True)
    v = x.var(dim=axis, keepdim=True, unbiased=False)
    return (x - m) / torch.sqrt(v + eps)
def _scatter_add(tgt, idx, src, axis=0):
    return tgt.clone().index_add_(axis, idx, src)
def _segment_sum(src, seg, n):
    out = torch.zeros((n,) + src.shape[1:], dtype=src.dtype)
    return out.index_add_(0, seg, src)
def _pad(x, pw):
    flat = tuple(v for pair in reversed(pw) for v in pair)
    return torch.nn.functional.pad(x, flat)

kernel_name = 'gather_scatter__cheap_equivariant_egnn__graph'

def setup_inputs():

    _w = (lambda a: (lambda t: t.to(torch.bfloat16) if t.is_floating_point() else t)(torch.as_tensor(a)))
    N, deg, D, De = 25000, 16, 128, max(16, 1)
    E = N * deg
    return {
        "h": _w((lambda *s: torch.randn(*s, dtype=torch.bfloat16) * 0.2)(N, D)),
        "pos": _w((lambda *s: torch.randn(*s, dtype=torch.bfloat16) * 0.4)(N, 3)),
        "e_attr": _w((lambda *s: torch.randn(*s, dtype=torch.bfloat16) * 0.4)(E, De)),
        "src": _w((lambda lo, hi, *s: torch.randint(lo, hi, s))(0, N, E).to(torch.int64)),
        "dst": _w((lambda lo, hi, *s: torch.randint(lo, hi, s))(0, N, E).to(torch.int64)),
        "w_e": _w(0.1 * (lambda *s: torch.randn(*s, dtype=torch.bfloat16) * 0.4)(2 * D + 1 + De, D)),
        "w_x": _w(0.1 * (lambda *s: torch.randn(*s, dtype=torch.bfloat16) * 0.2)(D, 1)),
        "w_h": _w(0.1 * (lambda *s: torch.randn(*s, dtype=torch.bfloat16) * 0.2)(2 * D, D)),
    }

def reference(h, pos, e_attr, src, dst, w_e, w_x, w_h):
    N, D = h.shape[0], h.shape[1]
    diff = pos[dst] - pos[src]
    dist2 = torch.sum(diff * diff, axis=-1, keepdims=True)
    e_in = torch.concatenate([h[dst], h[src], dist2, e_attr], axis=-1)
    m_ij = _silu(e_in @ w_e)
    coord_scale = m_ij @ w_x
    pos_new = pos + _segment_sum(diff * coord_scale, dst, N)
    m_i = _segment_sum(m_ij, dst, N)
    h_new = h + _silu(torch.concatenate([h, m_i], axis=-1) @ w_h)
    return h_new, pos_new
```

```asm
; @launch grid=(256,1,1) block=(512,1,1) lds=162048
.amdgcn_target "amdgcn-amd-amdhsa--gfx950"
.text
.globl gather_scatter__cheap_equivariant_egnn__graph_kernel
.p2align 8
.type gather_scatter__cheap_equivariant_egnn__graph_kernel,@function
gather_scatter__cheap_equivariant_egnn__graph_kernel:
s_cmp_ge_u32 s2, 256
s_cbranch_scc1 L_end
s_load_dwordx16 s[72:87], s[0:1], 0
s_load_dwordx4 s[28:31], s[0:1], 64
s_load_dwordx2 s[32:33], s[0:1], 80
v_lshrrev_b32 v1, 6, v0
v_and_b32 v2, 63, v0
v_readfirstlane_b32 s3, v1
s_mul_i32 s53, s2, 6400
v_lshl_add_u32 v6, v0, 4, s53
v_mov_b32 v15, 0x40000000
v_cmp_gt_u32 vcc, 400, v0
v_lshlrev_b32 v8, 2, v0
v_mov_b32 v10, 0
v_cndmask_b32 v6, v15, v6, vcc
ds_write_b32 v8, v10 offset:40960
ds_write_b32 v8, v10 offset:38912
s_mov_b32 s10, 1600000
s_mov_b32 s11, 0x20000
s_mov_b32 s14, 1600000
s_mov_b32 s15, 0x20000
s_getpc_b64 s[4:5]
L_cw0:
v_lshl_add_u32 v44, v2, 3, v1
v_mov_b32 v45, 0
v_add_u32 v44, 0, v44
v_min_u32 v44, (L_end-L_cw0)>>7, v44
v_lshlrev_b32 v44, 7, v44
s_mov_b64 exec, 0x7fffff
v_lshl_add_u64 v[44:45], v[44:45], 0, s[4:5]
global_load_dword v251, v[44:45], off
s_mov_b64 exec, -1
L_tb1:
L_tb2:
L_tb3:
L_tb4:
L_tb5:
s_cmp_ge_u32 s2, 250
s_waitcnt lgkmcnt(0)
s_cbranch_scc1 L_spec
s_mov_b32 s8, s80
s_mov_b32 s9, s81
s_mov_b32 s12, s78
s_mov_b32 s13, s79
buffer_load_dwordx4 v[16:19], v6, s[8:11], 0 offen
buffer_load_dwordx4 v[20:23], v6, s[12:15], 0 offen
s_lshl_b32 s88, s2, 3
s_add_u32 s88, s88, s3
s_cmp_eq_u32 s88, 7
s_cbranch_scc0 L_nond
s_memrealtime s[8:9]
s_mov_b32 s88, s30
s_mov_b32 s89, s31
s_movk_i32 s90, 256
s_mov_b32 s91, 0x20000
s_waitcnt lgkmcnt(0)
s_or_b32 s8, s8, 1
s_lshl_b32 s9, s9, 22
s_bitset1_b32 s9, 31
v_mov_b32 v40, s9
v_mov_b32 v41, s8
s_mov_b64 exec, 1
buffer_store_dwordx2 v[40:41], off, s[88:91], 0 sc0 sc1
s_mov_b64 exec, -1
L_nond:
s_mov_b64 s[80:81], vcc
s_barrier
s_mov_b32 s8, s82
s_mov_b32 s9, s83
s_mov_b32 s10, 65536
s_and_b32 s44, s2, 7
s_lshl_b32 s44, s44, 5
s_lshr_b32 s82, s2, 3
s_add_u32 s44, s44, s82
s_and_b32 s45, s3, 1
s_lshr_b32 s46, s3, 1
s_mov_b32 s60, -1
s_mov_b32 s61, 0
s_mov_b32 s20, s72
s_mov_b32 s21, s73
s_mov_b32 s22, 6400000
s_mov_b32 s23, 0x20000
v_lshlrev_b32 v14, 4, v2
v_lshrrev_b32 v56, 4, v2
v_and_b32 v57, 15, v2
s_lshl_b32 s82, s45, 4
v_lshl_add_u32 v58, v56, 2, s82
v_lshlrev_b32 v59, 8, v56
s_mov_b32 s88, 0x4a983210
s_mov_b32 s89, 0xc7654a98
s_mov_b32 s90, 0x10edc765
s_cmp_eq_u32 s46, 1
s_cselect_b32 s88, 0x10edc765, s88
s_cselect_b32 s89, 0x983210ed, s89
s_cselect_b32 s90, 0x210a9832, s90
s_cmp_eq_u32 s46, 2
s_cselect_b32 s88, 0x654a9832, s88
s_cselect_b32 s89, 0xedc7654a, s89
s_cselect_b32 s90, 0x7654a983, s90
s_cmp_eq_u32 s46, 3
s_cselect_b32 s88, 0x3210edc7, s88
s_cselect_b32 s89, 0x4a983210, s89
s_cselect_b32 s90, 0x83210edc, s90
s_mul_i32 s83, s44, 25088
s_lshl_b32 s57, s3, 10
s_add_u32 s84, s83, s57
v_bfe_u32 v60, s88, v58, 4
v_xor_b32 v60, v60, v57
v_lshl_add_u32 v60, v60, 4, v59
s_add_u32 m0, s57, 136960
s_add_u32 s82, s84, 0
buffer_load_dwordx4 v60, s[20:23], s82 offen lds
v_bfe_u32 v61, s89, v58, 4
v_xor_b32 v61, v61, v57
v_lshl_add_u32 v61, v61, 4, v59
s_add_u32 m0, s57, 145152
s_add_u32 s82, s84, 8192
buffer_load_dwordx4 v61, s[20:23], s82 offen lds
v_bfe_u32 v62, s90, v58, 4
v_xor_b32 v62, v62, v57
v_lshl_add_u32 v62, v62, 4, v59
s_add_u32 m0, s57, 153344
s_add_u32 s82, s84, 16384
buffer_load_dwordx4 v62, s[20:23], s82 offen lds
v_add_u32 v58, 9, v56
v_xor_b32 v58, v58, v57
v_lshl_add_u32 v63, v58, 4, v59
s_add_u32 s82, s83, 24576
s_mov_b32 m0, 161536
s_mov_b64 exec, s[60:61]
buffer_load_dwordx4 v63, s[20:23], s82 offen lds
s_mov_b64 exec, -1
s_mov_b32 s40, s74
s_mov_b32 s41, s75
s_mov_b32 s42, 150000
s_mov_b32 s43, 0x20000
s_mov_b32 s16, s32
s_mov_b32 s17, s33
s_mov_b32 s18, 28311552
s_mov_b32 s19, 0x20000
s_mov_b32 s24, s76
s_mov_b32 s25, s77
s_mov_b32 s26, 12800000
s_mov_b32 s27, 0x20000
s_mov_b32 s36, s28
s_mov_b32 s37, s29
s_mov_b32 s38, 6400000
s_mov_b32 s39, 0x20000
s_mov_b32 s12, s30
s_mov_b32 s13, s31
s_movk_i32 s14, 256
s_mov_b32 s30, 0
s_mul_i32 s47, s46, 28
s_min_u32 s47, s47, 77
v_lshlrev_b32 v1, 2, v2
v_lshlrev_b32 v99, 2, v56
v_xor_b32 v99, v99, v57
v_lshlrev_b32 v99, 4, v99
v_lshl_add_u32 v99, v56, 8, v99
v_mov_b32 v7, 1
s_mov_b32 s53, 42800
v_lshlrev_b32 v9, 4, v0
v_add_u32 v11, 2048, v8
v_and_b32 v197, 31, v2
v_lshrrev_b32 v47, 5, v2
v_lshrrev_b32 v40, 4, v197
v_bfe_u32 v41, v197, 2, 1
v_lshl_add_u32 v40, v40, 1, v41
v_and_b32 v41, 3, v197
v_bfe_u32 v42, v197, 3, 1
v_lshl_add_u32 v41, v42, 2, v41
v_mul_u32_u24 v43, 7, v40
v_add3_u32 v43, v43, v41, s47
v_min_u32 v43, 97, v43
v_and_b32 v44, 15, v197
v_xor_b32 v44, v44, v47
v_lshlrev_b32 v44, 4, v44
v_lshl_add_u32 v43, v43, 8, v44
v_add_u32 v3, 136960, v43
s_lshl_b32 s88, s3, 12
v_lshlrev_b32 v40, 4, v40
v_lshl_add_u32 v40, v41, 1, v40
v_add_u32 v240, s88, v40
v_bfe_u32 v40, v197, 2, 2
v_xor_b32 v40, v40, v47
v_lshlrev_b32 v40, 4, v40
v_lshl_add_u32 v40, v197, 6, v40
v_add_u32 v241, s88, v40
v_xor_b32 v242, 32, v241
v_mov_b32 v239, v240
v_bfe_u32 v40, v2, 2, 2
v_lshl_add_u32 v41, v47, 3, v40
v_lshlrev_b32 v41, 8, v41
v_bfe_u32 v42, v2, 4, 1
v_lshlrev_b32 v42, 1, v42
v_bfe_u32 v43, v2, 1, 1
v_add_u32 v42, v42, v43
v_lshl_add_u32 v41, v42, 4, v41
v_and_b32 v43, 1, v2
v_lshl_add_u32 v41, v43, 3, v41
s_lshl_b32 s88, s45, 1
v_xor_b32 v42, s88, v40
v_xor_b32 v43, 1, v42
v_lshl_add_u32 v12, v42, 6, v41
v_lshl_add_u32 v13, v43, 6, v41
s_cmp_lg_u32 s3, 6
s_cbranch_scc1 L_pad0
v_mov_b32 v46, 0x3f80
v_bfe_u32 v40, v2, 4, 1
v_bfe_u32 v41, v2, 1, 3
v_and_b32 v42, 1, v2
v_lshlrev_b32 v43, 11, v40
v_lshl_add_u32 v43, v41, 8, v43
v_lshl_add_u32 v43, v42, 7, v43
v_and_b32 v44, 3, v41
v_lshl_add_u32 v43, v44, 4, v43
v_xor_b32 v40, v40, v42
v_lshl_add_u32 v40, v40, 4, v41
v_cmp_eq_u32 vcc, 0, v40
s_nop 1
v_cndmask_b32 v36, 0, v46, vcc
v_cmp_eq_u32 vcc, 1, v40
s_nop 1
v_cndmask_b32 v36, v36, 1.0, vcc
v_cmp_eq_u32 vcc, 2, v40
s_nop 1
v_cndmask_b32 v37, 0, v46, vcc
v_cmp_eq_u32 vcc, 3, v40
s_nop 1
v_cndmask_b32 v37, v37, 1.0, vcc
v_cmp_eq_u32 vcc, 4, v40
s_nop 1
v_cndmask_b32 v38, 0, v46, vcc
v_cmp_eq_u32 vcc, 5, v40
s_nop 1
v_cndmask_b32 v38, v38, 1.0, vcc
v_cmp_eq_u32 vcc, 6, v40
s_nop 1
v_cndmask_b32 v39, 0, v46, vcc
ds_write_b128 v43, v[36:39] offset:32768
L_pad0:
s_mov_b32 s68, 0xffff0000
s_mov_b32 s64, 0xbfb8aa3b
s_mov_b32 s65, 0xbfb8aa3b
s_lshr_b32 s88, s44, 3
s_mul_i32 s88, s88, 16000
s_and_b32 s89, s44, 7
s_lshl_b32 s89, s89, 3
s_add_u32 s88, s88, s89
s_add_u32 s34, s88, 27262976
s_mov_b32 s54, 0x7fff0000
s_waitcnt vmcnt(5)
v_mul_u32_u24 v24, s53, v16
v_lshrrev_b32 v24, 22, v24
v_lshlrev_b32 v28, 2, v24
v_mul_u32_u24 v25, s53, v17
v_lshrrev_b32 v25, 22, v25
v_lshlrev_b32 v29, 2, v25
v_mul_u32_u24 v26, s53, v18
v_lshrrev_b32 v26, 22, v26
v_lshlrev_b32 v30, 2, v26
v_mul_u32_u24 v27, s53, v19
v_lshrrev_b32 v27, 22, v27
v_lshlrev_b32 v31, 2, v27
s_mov_b64 exec, s[80:81]
ds_add_rtn_u32 v32, v28, v7 offset:41472
ds_add_rtn_u32 v33, v29, v7 offset:41472
ds_add_rtn_u32 v34, v30, v7 offset:41472
ds_add_rtn_u32 v35, v31, v7 offset:41472
s_mov_b64 exec, -1
s_add_u32 m0, s57, 0
s_add_u32 s82, s57, 32768
buffer_load_dwordx4 v99, s[8:11], s82 offen lds
s_add_u32 m0, s57, 8192
s_add_u32 s82, s57, 40960
buffer_load_dwordx4 v99, s[8:11], s82 offen lds
s_add_u32 m0, s57, 16384
s_add_u32 s82, s57, 49152
buffer_load_dwordx4 v99, s[8:11], s82 offen lds
s_add_u32 m0, s57, 24576
s_add_u32 s82, s57, 57344
buffer_load_dwordx4 v99, s[8:11], s82 offen lds
s_cmp_eq_u32 s3, 7
s_cbranch_scc0 L_n1n
buffer_load_dwordx2 v[172:173], off, s[12:15], 0 sc1
s_waitcnt vmcnt(9)
s_branch L_n1ld
L_n1n:
s_waitcnt vmcnt(8)
v_mul_u32_u24 v56, 98, v24
v_sub_u32 v16, v16, v56
v_mul_u32_u24 v56, 147, v16
v_lshrrev_b32 v56, 10, v56
v_mul_u32_u24 v57, 7, v56
v_sub_u32 v16, v16, v57
v_add_u32 v57, 5, v56
v_lshrrev_b32 v57, 4, v57
v_add_u32 v56, v56, v57
v_lshl_add_u32 v56, v56, 3, v16
v_lshl_or_b32 v20, v56, 24, v20
v_and_b32 v16, 3, v16
v_lshl_or_b32 v160, v16, 20, v20
s_waitcnt lgkmcnt(0)
L_n1ld:
s_barrier
ds_read_b128 v[36:39], v14 offset:41472
v_mul_u32_u24 v58, 98, v25
v_sub_u32 v17, v17, v58
v_mul_u32_u24 v58, 147, v17
v_lshrrev_b32 v58, 10, v58
v_mul_u32_u24 v59, 7, v58
v_sub_u32 v17, v17, v59
v_add_u32 v59, 5, v58
v_lshrrev_b32 v59, 4, v59
v_add_u32 v58, v58, v59
v_lshl_add_u32 v58, v58, 3, v17
v_lshl_or_b32 v21, v58, 24, v21
v_and_b32 v17, 3, v17
v_lshl_or_b32 v162, v17, 20, v21
s_waitcnt lgkmcnt(0)
v_add_u32 v60, v36, v37
v_add_u32 v61, v60, v38
v_add_u32 v63, v61, v39
v_mov_b32 v62, v63
v_mul_u32_u24 v56, 98, v26
v_add_u32_dpp v63, v63, v63 row_shr:1 row_mask:0xf bank_mask:0xf bound_ctrl:1
v_sub_u32 v18, v18, v56
v_mul_u32_u24 v56, 147, v18
v_add_u32_dpp v63, v63, v63 row_shr:2 row_mask:0xf bank_mask:0xf bound_ctrl:1
v_lshrrev_b32 v56, 10, v56
v_mul_u32_u24 v57, 7, v56
v_add_u32_dpp v63, v63, v63 row_shr:4 row_mask:0xf bank_mask:0xf bound_ctrl:1
v_sub_u32 v18, v18, v57
v_add_u32 v57, 5, v56
v_add_u32_dpp v63, v63, v63 row_shr:8 row_mask:0xf bank_mask:0xf bound_ctrl:1
v_lshrrev_b32 v57, 4, v57
v_add_u32 v56, v56, v57
v_add_u32_dpp v63, v63, v63 row_bcast:15 row_mask:0xa bank_mask:0xf
v_lshl_add_u32 v56, v56, 3, v18
v_lshl_or_b32 v22, v56, 24, v22
v_add_u32_dpp v63, v63, v63 row_bcast:31 row_mask:0xc bank_mask:0xf
v_sub_u32 v48, v63, v62
v_add_u32 v49, v48, v36
v_add_u32 v50, v48, v60
v_add_u32 v51, v48, v61
v_mov_b32 v72, v15
v_mov_b32 v61, 0
s_cmp_eq_u32 s3, 7
s_cbranch_scc0 L_pkn
v_lshl_or_b32 v64, v36, 11, v48
v_lshl_or_b32 v66, v37, 11, v49
v_lshl_or_b32 v68, v38, 11, v50
v_lshl_or_b32 v70, v39, 11, v51
v_lshrrev_b32 v72, 1, v2
s_movk_i32 s53, 16000
v_mul_u32_u24 v72, s53, v72
v_and_b32 v73, 1, v2
v_lshl_add_u32 v72, v73, 5, v72
s_lshl_b32 s53, s2, 6
s_add_u32 s53, s53, 27262976
s_branch L_pkd
L_pkn:
ds_write_b128 v14, v[48:51] offset:42496
ds_read_b32 v52, v28 offset:42496
ds_read_b32 v53, v29 offset:42496
ds_read_b32 v54, v30 offset:42496
ds_read_b32 v55, v31 offset:42496
v_and_b32 v18, 3, v18
v_lshl_or_b32 v164, v18, 20, v22
v_mul_u32_u24 v58, 98, v27
v_sub_u32 v19, v19, v58
v_mul_u32_u24 v58, 147, v19
v_lshrrev_b32 v58, 10, v58
v_mul_u32_u24 v59, 7, v58
v_sub_u32 v19, v19, v59
v_add_u32 v59, 5, v58
v_lshrrev_b32 v59, 4, v59
v_add_u32 v58, v58, v59
v_lshl_add_u32 v58, v58, 3, v19
v_lshl_or_b32 v23, v58, 24, v23
v_and_b32 v19, 3, v19
v_lshl_or_b32 v166, v19, 20, v23
s_mov_b32 s56, 84608
s_waitcnt lgkmcnt(0)
s_mov_b64 exec, s[80:81]
v_add_u32 v32, v32, v52
v_lshl_add_u32 v28, v32, 3, s56
v_sub_u32 v161, v11, v32
ds_write_b64 v28, v[160:161]
v_add_u32 v33, v33, v53
v_lshl_add_u32 v29, v33, 3, s56
v_sub_u32 v163, v11, v33
v_add_u32 v163, 1, v163
ds_write_b64 v29, v[162:163]
v_add_u32 v34, v34, v54
v_lshl_add_u32 v30, v34, 3, s56
v_sub_u32 v165, v11, v34
v_add_u32 v165, 2, v165
ds_write_b64 v30, v[164:165]
v_add_u32 v35, v35, v55
v_lshl_add_u32 v31, v35, 3, s56
v_sub_u32 v167, v11, v35
v_add_u32 v167, 3, v167
ds_write_b64 v31, v[166:167]
s_mov_b64 exec, -1
L_pkd:
s_mul_i32 s56, s2, 12800
v_cmp_gt_u32 vcc, 0x120, v0
s_add_u32 s56, s56, 8388608
v_add_u32 v10, 8192, v9
v_add_u32 v103, 84608, v9
v_cndmask_b32 v10, v15, v10, vcc
s_add_u32 m0, s57, 51840
s_add_u32 s82, s57, 0
buffer_load_dwordx4 v99, s[8:11], s82 offen lds
s_add_u32 m0, s57, 60032
s_add_u32 s82, s57, 8192
buffer_load_dwordx4 v99, s[8:11], s82 offen lds
s_add_u32 m0, s57, 68224
s_add_u32 s82, s57, 16384
buffer_load_dwordx4 v99, s[8:11], s82 offen lds
s_add_u32 m0, s57, 76416
s_add_u32 s82, s57, 24576
buffer_load_dwordx4 v99, s[8:11], s82 offen lds
s_mov_b32 s8, s32
s_mov_b32 s9, s33
s_mov_b32 s10, 6400000
v_lshrrev_b32 v40, 3, v0
s_mul_i32 s88, s44, 98
v_sub_u32 v40, v0, v40
v_cmp_lt_u32 vcc, 95, v0
v_add_u32 v40, s88, v40
v_subrev_u32 v41, 7, v40
v_cndmask_b32 v40, v40, v41, vcc
v_cmp_gt_u32 vcc, 120, v0
v_and_b32 v102, 1, v40
v_mul_u32_u24 v40, 6, v40
v_lshlrev_b32 v102, 4, v102
v_and_b32 v40, -4, v40
v_cndmask_b32 v40, v15, v40, vcc
buffer_load_dwordx2 v[100:101], v40, s[40:43], 0 offen
v_lshrrev_b32 v6, 1, v0
v_cmp_gt_u32 vcc, 250, v6
v_lshlrev_b32 v98, 6, v6
v_mul_u32_u24 v6, 1600, v6
s_mov_b64 s[78:79], vcc
v_cndmask_b32 v98, v15, v98, vcc
s_branch L_sg1
L_n1p:
s_add_u32 s30, s30, 1
s_cmp_gt_u32 s30, 2000000
s_cbranch_scc1 L_end
buffer_load_dwordx2 v[172:173], off, s[12:15], 0 sc1
s_waitcnt vmcnt(0)
v_cmp_eq_u32 vcc, 0, v172
s_cbranch_vccnz L_n1p
s_branch L_n1d
.p2align 12
L_t1:
s_branch L_tb1
s_nop 0
L_sg1:
s_cmp_eq_u32 s3, 7
s_waitcnt vmcnt(5)
s_cbranch_scc0 L_w7d
v_cmp_eq_u32 vcc, 0, v172
s_cbranch_vccnz L_n1p
L_n1d:
ds_write_b64 v61, v[172:173] offset:41200
v_or_b32 v64, v64, v172
v_mov_b32 v65, v173
v_or_b32 v66, v66, v172
v_mov_b32 v67, v173
v_or_b32 v68, v68, v172
v_mov_b32 v69, v173
v_or_b32 v70, v70, v172
v_mov_b32 v71, v173
buffer_store_dwordx4 v[64:67], v72, s[16:19], s53 offen sc0 sc1
buffer_store_dwordx4 v[68:71], v72, s[16:19], s53 offen offset:16 sc0 sc1
L_w7d:
s_waitcnt lgkmcnt(0)
s_barrier
L_gemm:
ds_read_b128 v[16:19], v103 offset:0
ds_read_b128 v[20:23], v103 offset:8192
ds_read_b64 v[172:173], v61 offset:41200
ds_read_b128 v[120:123], v3
ds_read_b64_tr_b16 v[64:65], v12 offset:0
ds_read_b64_tr_b16 v[66:67], v12 offset:1024
ds_read_b64_tr_b16 v[68:69], v13 offset:0
ds_read_b64_tr_b16 v[70:71], v13 offset:1024
v_xor_b32 v57, 32, v3
ds_read_b128 v[124:127], v57
ds_read_b64_tr_b16 v[72:73], v12 offset:4096
ds_read_b64_tr_b16 v[74:75], v12 offset:5120
ds_read_b64_tr_b16 v[76:77], v13 offset:4096
ds_read_b64_tr_b16 v[78:79], v13 offset:5120
s_waitcnt lgkmcnt(10)
v_readfirstlane_b32 s67, v173
v_readfirstlane_b32 s66, v172
s_mov_b32 s14, 0x80cf8000
s_lshr_b32 s12, s67, 5
s_lshl_b32 s13, s67, 12
s_and_b32 s12, s12, s14
v_xor_b32 v16, s12, v16
v_xor_b32 v17, s13, v17
v_xor_b32 v18, s12, v18
v_xor_b32 v19, s13, v19
buffer_store_dwordx4 v[16:19], v9, s[16:19], s56 offen sc0 sc1
v_xor_b32 v20, s12, v20
v_xor_b32 v21, s13, v21
v_xor_b32 v22, s12, v22
v_xor_b32 v23, s13, v23
buffer_store_dwordx4 v[20:23], v10, s[16:19], s56 offen sc0 sc1
v_xor_b32 v56, 64, v3
ds_read_b128 v[128:131], v56
ds_read_b64_tr_b16 v[80:81], v12 offset:8192
ds_read_b64_tr_b16 v[82:83], v12 offset:9216
ds_read_b64_tr_b16 v[84:85], v13 offset:8192
ds_read_b64_tr_b16 v[86:87], v13 offset:9216
s_waitcnt lgkmcnt(10)
v_mfma_f32_32x32x16_bf16 v[200:215], v[120:123], v[64:67], 0
v_mfma_f32_32x32x16_bf16 v[216:231], v[120:123], v[68:71], 0
s_mul_i32 s88, s44, 98
s_add_u32 s88, s88, s47
s_lshl_b32 s88, s88, 8
v_xor_b32 v57, 96, v3
ds_read_b128 v[132:135], v57
ds_read_b64_tr_b16 v[88:89], v12 offset:12288
ds_read_b64_tr_b16 v[90:91], v12 offset:13312
ds_read_b64_tr_b16 v[92:93], v13 offset:12288
ds_read_b64_tr_b16 v[94:95], v13 offset:13312
s_waitcnt lgkmcnt(10)
v_mfma_f32_32x32x16_bf16 v[200:215], v[124:127], v[72:75], v[200:215]
v_mfma_f32_32x32x16_bf16 v[216:231], v[124:127], v[76:79], v[216:231]
s_lshl_b32 s89, s45, 7
s_add_u32 s88, s88, s89
v_mul_u32_u24 v40, 1792, v47
v_xor_b32 v56, 128, v3
ds_read_b128 v[136:139], v56
ds_read_b64_tr_b16 v[64:65], v12 offset:16384
ds_read_b64_tr_b16 v[66:67], v12 offset:17408
ds_read_b64_tr_b16 v[68:69], v13 offset:16384
ds_read_b64_tr_b16 v[70:71], v13 offset:17408
s_waitcnt lgkmcnt(10)
v_mfma_f32_32x32x16_bf16 v[200:215], v[128:131], v[80:83], v[200:215]
v_mfma_f32_32x32x16_bf16 v[216:231], v[128:131], v[84:87], v[216:231]
v_lshl_add_u32 v40, v197, 2, v40
v_add_u32 v4, s88, v40
s_cmp_ge_u32 s46, 2
v_xor_b32 v57, 160, v3
ds_read_b128 v[140:143], v57
ds_read_b64_tr_b16 v[72:73], v12 offset:20480
ds_read_b64_tr_b16 v[74:75], v12 offset:21504
ds_read_b64_tr_b16 v[76:77], v13 offset:20480
ds_read_b64_tr_b16 v[78:79], v13 offset:21504
s_waitcnt lgkmcnt(10)
v_mfma_f32_32x32x16_bf16 v[200:215], v[132:135], v[88:91], v[200:215]
v_mfma_f32_32x32x16_bf16 v[216:231], v[132:135], v[92:95], v[216:231]
s_cselect_b32 s89, 0x40000000, 0
v_mul_lo_u32 v40, v47, s89
v_add_u32 v5, 3584, v4
v_xor_b32 v56, 192, v3
ds_read_b128 v[144:147], v56
ds_read_b64_tr_b16 v[80:81], v12 offset:24576
ds_read_b64_tr_b16 v[82:83], v12 offset:25600
ds_read_b64_tr_b16 v[84:85], v13 offset:24576
ds_read_b64_tr_b16 v[86:87], v13 offset:25600
s_waitcnt lgkmcnt(10)
v_mfma_f32_32x32x16_bf16 v[200:215], v[136:139], v[64:67], v[200:215]
v_mfma_f32_32x32x16_bf16 v[216:231], v[136:139], v[68:71], v[216:231]
v_add_u32 v5, v5, v40
s_mov_b64 s[58:59], s[60:61]
s_mov_b32 s48, 0
v_xor_b32 v57, 224, v3
ds_read_b128 v[148:151], v57
ds_read_b64_tr_b16 v[88:89], v12 offset:28672
ds_read_b64_tr_b16 v[90:91], v12 offset:29696
ds_read_b64_tr_b16 v[92:93], v13 offset:28672
ds_read_b64_tr_b16 v[94:95], v13 offset:29696
s_waitcnt lgkmcnt(10)
v_mfma_f32_32x32x16_bf16 v[200:215], v[140:143], v[72:75], v[200:215]
v_mfma_f32_32x32x16_bf16 v[216:231], v[140:143], v[76:79], v[216:231]
s_movk_i32 s49, 320
s_mov_b32 s50, 1
s_mul_i32 s52, s3, 1296
s_waitcnt lgkmcnt(5)
v_mfma_f32_32x32x16_bf16 v[200:215], v[144:147], v[80:83], v[200:215]
v_mfma_f32_32x32x16_bf16 v[216:231], v[144:147], v[84:87], v[216:231]
s_mov_b32 s91, -65536
s_waitcnt lgkmcnt(0)
v_mfma_f32_32x32x16_bf16 v[200:215], v[148:151], v[88:91], v[200:215]
v_mfma_f32_32x32x16_bf16 v[216:231], v[148:151], v[92:95], v[216:231]
s_cmp_ge_u32 s2, 250
s_cbranch_scc1 L_wff
L_wffd:
buffer_load_dwordx2 v[96:97], v98, s[16:19], s34 offen sc1
s_nop 7
v_pk_mul_f32 v[200:201], v[200:201], s[64:65]
v_pk_mul_f32 v[216:217], v[216:217], s[64:65]
v_pk_mul_f32 v[202:203], v[202:203], s[64:65]
v_pk_mul_f32 v[218:219], v[218:219], s[64:65]
v_pk_mul_f32 v[204:205], v[204:205], s[64:65]
v_pk_mul_f32 v[220:221], v[220:221], s[64:65]
v_pk_mul_f32 v[206:207], v[206:207], s[64:65]
v_pk_mul_f32 v[222:223], v[222:223], s[64:65]
v_pk_mul_f32 v[208:209], v[208:209], s[64:65]
v_pk_mul_f32 v[224:225], v[224:225], s[64:65]
v_pk_mul_f32 v[210:211], v[210:211], s[64:65]
v_pk_mul_f32 v[226:227], v[226:227], s[64:65]
v_pk_mul_f32 v[212:213], v[212:213], s[64:65]
v_pk_mul_f32 v[228:229], v[228:229], s[64:65]
v_pk_mul_f32 v[214:215], v[214:215], s[64:65]
v_pk_mul_f32 v[230:231], v[230:231], s[64:65]
v_cvt_pk_bf16_f32 v200, v200, v216
v_and_b32 v216, 0x7fffffff, v216
v_add_u32 v216, 0x8000, v216
v_sub_u32_sdwa v216, v216, v200 clamp dst_sel:DWORD dst_unused:UNUSED_PAD src0_sel:DWORD src1_sel:WORD_0
v_bfi_b32 v200, s54, v216, v200
buffer_store_dword v200, v4, s[8:11], 0 offen offset:0 sc0 sc1
v_cvt_pk_bf16_f32 v201, v201, v217
v_and_b32 v217, 0x7fffffff, v217
v_add_u32 v217, 0x8000, v217
v_sub_u32_sdwa v217, v217, v201 clamp dst_sel:DWORD dst_unused:UNUSED_PAD src0_sel:DWORD src1_sel:WORD_0
v_bfi_b32 v201, s54, v217, v201
buffer_store_dword v201, v4, s[8:11], 0 offen offset:256 sc0 sc1
v_cvt_pk_bf16_f32 v202, v202, v218
v_and_b32 v218, 0x7fffffff, v218
v_add_u32 v218, 0x8000, v218
v_sub_u32_sdwa v218, v218, v202 clamp dst_sel:DWORD dst_unused:UNUSED_PAD src0_sel:DWORD src1_sel:WORD_0
v_bfi_b32 v202, s54, v218, v202
buffer_store_dword v202, v4, s[8:11], 0 offen offset:512 sc0 sc1
v_cvt_pk_bf16_f32 v203, v203, v219
v_and_b32 v219, 0x7fffffff, v219
v_add_u32 v219, 0x8000, v219
v_sub_u32_sdwa v219, v219, v203 clamp dst_sel:DWORD dst_unused:UNUSED_PAD src0_sel:DWORD src1_sel:WORD_0
v_bfi_b32 v203, s54, v219, v203
buffer_store_dword v203, v4, s[8:11], 0 offen offset:768 sc0 sc1
v_cvt_pk_bf16_f32 v204, v204, v220
v_and_b32 v220, 0x7fffffff, v220
v_add_u32 v220, 0x8000, v220
v_sub_u32_sdwa v220, v220, v204 clamp dst_sel:DWORD dst_unused:UNUSED_PAD src0_sel:DWORD src1_sel:WORD_0
v_bfi_b32 v204, s54, v220, v204
buffer_store_dword v204, v4, s[8:11], 0 offen offset:1024 sc0 sc1
v_cvt_pk_bf16_f32 v205, v205, v221
v_and_b32 v221, 0x7fffffff, v221
v_add_u32 v221, 0x8000, v221
v_sub_u32_sdwa v221, v221, v205 clamp dst_sel:DWORD dst_unused:UNUSED_PAD src0_sel:DWORD src1_sel:WORD_0
v_bfi_b32 v205, s54, v221, v205
buffer_store_dword v205, v4, s[8:11], 0 offen offset:1280 sc0 sc1
v_cvt_pk_bf16_f32 v206, v206, v222
v_and_b32 v222, 0x7fffffff, v222
v_add_u32 v222, 0x8000, v222
v_sub_u32_sdwa v222, v222, v206 clamp dst_sel:DWORD dst_unused:UNUSED_PAD src0_sel:DWORD src1_sel:WORD_0
v_bfi_b32 v206, s54, v222, v206
buffer_store_dword v206, v4, s[8:11], 0 offen offset:1536 sc0 sc1
v_cvt_pk_bf16_f32 v208, v208, v224
v_and_b32 v224, 0x7fffffff, v224
v_add_u32 v224, 0x8000, v224
v_sub_u32_sdwa v224, v224, v208 clamp dst_sel:DWORD dst_unused:UNUSED_PAD src0_sel:DWORD src1_sel:WORD_0
v_bfi_b32 v208, s54, v224, v208
buffer_store_dword v208, v5, s[8:11], 0 offen offset:0 sc0 sc1
v_cvt_pk_bf16_f32 v209, v209, v225
v_and_b32 v225, 0x7fffffff, v225
v_add_u32 v225, 0x8000, v225
v_sub_u32_sdwa v225, v225, v209 clamp dst_sel:DWORD dst_unused:UNUSED_PAD src0_sel:DWORD src1_sel:WORD_0
v_bfi_b32 v209, s54, v225, v209
buffer_store_dword v209, v5, s[8:11], 0 offen offset:256 sc0 sc1
v_cvt_pk_bf16_f32 v210, v210, v226
v_and_b32 v226, 0x7fffffff, v226
v_add_u32 v226, 0x8000, v226
v_sub_u32_sdwa v226, v226, v210 clamp dst_sel:DWORD dst_unused:UNUSED_PAD src0_sel:DWORD src1_sel:WORD_0
v_bfi_b32 v210, s54, v226, v210
buffer_store_dword v210, v5, s[8:11], 0 offen offset:512 sc0 sc1
v_cvt_pk_bf16_f32 v211, v211, v227
v_and_b32 v227, 0x7fffffff, v227
v_add_u32 v227, 0x8000, v227
v_sub_u32_sdwa v227, v227, v211 clamp dst_sel:DWORD dst_unused:UNUSED_PAD src0_sel:DWORD src1_sel:WORD_0
v_bfi_b32 v211, s54, v227, v211
buffer_store_dword v211, v5, s[8:11], 0 offen offset:768 sc0 sc1
v_cvt_pk_bf16_f32 v212, v212, v228
v_and_b32 v228, 0x7fffffff, v228
v_add_u32 v228, 0x8000, v228
v_sub_u32_sdwa v228, v228, v212 clamp dst_sel:DWORD dst_unused:UNUSED_PAD src0_sel:DWORD src1_sel:WORD_0
v_bfi_b32 v212, s54, v228, v212
buffer_store_dword v212, v5, s[8:11], 0 offen offset:1024 sc0 sc1
v_cvt_pk_bf16_f32 v213, v213, v229
v_and_b32 v229, 0x7fffffff, v229
v_add_u32 v229, 0x8000, v229
v_sub_u32_sdwa v229, v229, v213 clamp dst_sel:DWORD dst_unused:UNUSED_PAD src0_sel:DWORD src1_sel:WORD_0
v_bfi_b32 v213, s54, v229, v213
buffer_store_dword v213, v5, s[8:11], 0 offen offset:1280 sc0 sc1
v_cvt_pk_bf16_f32 v214, v214, v230
v_and_b32 v230, 0x7fffffff, v230
v_add_u32 v230, 0x8000, v230
v_sub_u32_sdwa v230, v230, v214 clamp dst_sel:DWORD dst_unused:UNUSED_PAD src0_sel:DWORD src1_sel:WORD_0
v_bfi_b32 v214, s54, v230, v214
buffer_store_dword v214, v5, s[8:11], 0 offen offset:1536 sc0 sc1
s_lshr_b32 s88, s2, 3
s_mul_i32 s88, s88, 4736
s_cmp_eq_u32 s3, 5
s_cselect_b32 s89, 37, 0
v_cmp_gt_u32 vcc, s89, v2
v_lshlrev_b32 v44, 7, v2
s_nop 0
v_cndmask_b32 v44, v15, v44, vcc
buffer_load_dword v251, v44, s[40:43], s88 offen
s_waitcnt vmcnt(18)
v_alignbit_b32 v100, v101, v100, v102
v_lshrrev_b32 v101, v102, v101
v_lshlrev_b32 v104, 16, v100
v_and_b32 v105, s68, v100
v_cmp_gt_u32 vcc, 128, v0
v_lshlrev_b32 v106, 16, v101
v_mov_b32 v107, 0
s_mov_b64 exec, vcc
ds_write_b128 v9, v[104:107] offset:36864
s_mov_b64 exec, -1
L_round:
s_and_b32 s88, s2, 7
s_lshl_b32 s88, s88, 8
v_min_u32 v29, 2, v2
s_add_u32 s88, s88, 27983872
v_add_u32 v30, 51840, v12
v_lshl_add_u32 v29, v29, 3, s88
v_add_u32 v31, 51840, v13
v_and_b32 v12, 1, v0
v_cmp_eq_u32 s[86:87], 0, v12
s_waitcnt vmcnt(15)
v_bfe_u32 v10, v96, 11, 11
v_and_b32 v9, 0x7ff, v96
v_and_b32 v96, 0xffc00000, v96
v_cmp_ne_u64 vcc, s[66:67], v[96:97]
v_add_u32 v9, v9, v6
v_cndmask_b32 v11, 0, v10, s[86:87]
s_and_b64 vcc, vcc, s[78:79]
s_cbranch_vccz L_tbd
L_tbp:
s_add_u32 s30, s30, 1
s_cmp_gt_u32 s30, 2000000
s_cbranch_scc1 L_end
buffer_load_dwordx2 v[96:97], v98, s[16:19], s34 offen sc1
s_waitcnt vmcnt(0)
v_bfe_u32 v10, v96, 11, 11
v_and_b32 v9, 0x7ff, v96
v_and_b32 v96, 0xffc00000, v96
v_cmp_ne_u64 vcc, s[66:67], v[96:97]
v_add_u32 v9, v9, v6
v_cndmask_b32 v11, 0, v10, s[86:87]
s_and_b64 vcc, vcc, s[78:79]
s_cbranch_vccnz L_tbp
L_tbd:
v_add_u32_dpp v11, v11, v11 row_shr:1 row_mask:0xf bank_mask:0xf bound_ctrl:1
v_mov_b32 v252, 0
v_mov_b32 v253, 0
v_add_u32_dpp v11, v11, v11 row_shr:2 row_mask:0xf bank_mask:0xf bound_ctrl:1
v_mov_b32 v254, 0
v_mov_b32 v255, 0
v_add_u32_dpp v11, v11, v11 row_shr:4 row_mask:0xf bank_mask:0xf bound_ctrl:1
v_add_u32 v44, s52, v1
s_mov_b32 s85, 8388608
v_add_u32_dpp v11, v11, v11 row_shr:8 row_mask:0xf bank_mask:0xf bound_ctrl:1
s_nop 0
s_nop 0
v_add_u32_dpp v11, v11, v11 row_bcast:15 row_mask:0xa bank_mask:0xf
s_nop 0
s_nop 0
v_add_u32_dpp v11, v11, v11 row_bcast:31 row_mask:0xc bank_mask:0xf
v_sub_u32 v13, v10, v12
v_readlane_b32 s82, v11, 63
v_sub_u32 v11, v11, v10
s_sub_u32 s83, s82, s48
s_min_u32 s51, s83, s49
s_sub_u32 s35, s83, s51
v_subrev_u32 v11, s48, v11
v_sub_u32 v9, v9, v11
v_add_lshl_u32 v11, v11, v12, 2
s_cmp_lg_u32 s82, s51
s_cbranch_scc1 L_exp
v_add_u32 v7, s52, v11
v_cmpx_lt_i32 vcc, 0, v13
ds_write_b32 v7, v9 offset:41472
v_cmpx_lt_i32 vcc, 2, v13
ds_write_b32 v7, v9 offset:41480
v_cmpx_lt_i32 vcc, 4, v13
ds_write_b32 v7, v9 offset:41488
v_cmpx_lt_i32 vcc, 6, v13
ds_write_b32 v7, v9 offset:41496
v_cmpx_lt_i32 vcc, 8, v13
ds_write_b32 v7, v9 offset:41504
v_cmpx_lt_i32 vcc, 10, v13
ds_write_b32 v7, v9 offset:41512
v_cmpx_lt_i32 vcc, 12, v13
ds_write_b32 v7, v9 offset:41520
v_cmpx_lt_i32 vcc, 14, v13
ds_write_b32 v7, v9 offset:41528
v_cmpx_lt_i32 vcc, 16, v13
s_cbranch_execnz L_exp2
L_expd:
s_mov_b64 exec, -1
ds_read_b32 v24, v44 offset:41472
ds_read_b32 v25, v44 offset:41728
ds_read_b32 v26, v44 offset:41984
ds_read_b32 v27, v44 offset:42240
ds_read_b32 v28, v44 offset:42496
s_sub_u32 s82, s51, 0
v_cmp_gt_i32 s[72:73], s82, v2
s_sub_u32 s82, s51, 64
v_cmp_gt_i32 s[74:75], s82, v2
s_sub_u32 s82, s51, 128
v_cmp_gt_i32 s[76:77], s82, v2
s_sub_u32 s82, s51, 192
v_cmp_gt_i32 s[78:79], s82, v2
s_sub_u32 s82, s51, 256
v_cmp_gt_i32 s[80:81], s82, v2
s_waitcnt lgkmcnt(4)
v_add_u32 v24, v24, v2
v_lshlrev_b32 v80, 3, v24
v_lshl_add_u32 v24, v24, 5, s91
v_cndmask_b32 v80, v15, v80, s[72:73]
buffer_load_dwordx2 v[80:81], v80, s[16:19], s85 offen sc1
s_waitcnt lgkmcnt(3)
v_add3_u32 v25, v25, v2, 64
v_lshlrev_b32 v84, 3, v25
v_lshl_add_u32 v25, v25, 5, s91
v_cndmask_b32 v84, v15, v84, s[74:75]
buffer_load_dwordx2 v[84:85], v84, s[16:19], s85 offen sc1
s_movk_i32 s82, 128
s_waitcnt lgkmcnt(2)
v_add3_u32 v26, v26, v2, s82
v_lshlrev_b32 v88, 3, v26
v_lshl_add_u32 v26, v26, 5, s91
v_cndmask_b32 v88, v15, v88, s[76:77]
buffer_load_dwordx2 v[88:89], v88, s[16:19], s85 offen sc1
s_movk_i32 s82, 192
s_waitcnt lgkmcnt(1)
v_add3_u32 v27, v27, v2, s82
v_lshlrev_b32 v92, 3, v27
v_lshl_add_u32 v27, v27, 5, s91
v_cndmask_b32 v92, v15, v92, s[78:79]
buffer_load_dwordx2 v[92:93], v92, s[16:19], s85 offen sc1
s_movk_i32 s82, 256
s_waitcnt lgkmcnt(0)
v_add3_u32 v28, v28, v2, s82
v_lshlrev_b32 v96, 3, v28
v_lshl_add_u32 v28, v28, 5, s91
v_cndmask_b32 v96, v15, v96, s[80:81]
s_cmp_gt_u32 s51, 256
s_cbranch_scc1 L_5a
L_5ad:
s_mov_b32 s62, 0x01111111
s_mov_b32 s63, 0x01111111
s_mov_b32 s69, 0xbf80
s_mov_b32 s70, 0xbf800000
s_lshl_b32 s88, s45, 7
s_add_u32 s4, s32, s88
s_addc_u32 s5, s33, 0
s_and_b32 s5, s5, 0xffff
s_or_b32 s5, s5, 0x80000000
s_mov_b32 s6, 6400000
s_mov_b32 s7, 0xC00000
s_lshl_b32 s71, s45, 13
s_add_u32 s71, s71, 27869184
v_lshrrev_b32 v40, 2, v197
v_lshlrev_b32 v41, 2, v47
s_lshl_b32 s88, s45, 3
v_xor_b32 v40, v40, v41
s_add_u32 s89, s47, 535
v_xor_b32 v40, s88, v40
v_mad_u32_u24 v41, v47, 7, s89
v_and_b32 v42, 3, v197
v_lshlrev_b32 v40, 4, v40
v_lshl_add_u32 v40, v42, 2, v40
v_lshl_add_u32 v40, v41, 8, v40
ds_read_b32 v176, v40 offset:0
ds_read_b32 v183, v40 offset:3584
v_xor_b32 v42, 16, v40
ds_read_b32 v177, v42 offset:256
ds_read_b32 v184, v42 offset:3840
v_xor_b32 v41, 32, v40
ds_read_b32 v178, v41 offset:512
ds_read_b32 v185, v41 offset:4096
v_xor_b32 v42, 48, v40
ds_read_b32 v179, v42 offset:768
ds_read_b32 v186, v42 offset:4352
v_xor_b32 v41, 128, v40
ds_read_b32 v180, v41 offset:1024
ds_read_b32 v187, v41 offset:4608
v_xor_b32 v42, 144, v40
ds_read_b32 v181, v42 offset:1280
ds_read_b32 v188, v42 offset:4864
v_xor_b32 v41, 160, v40
ds_read_b32 v182, v41 offset:1536
ds_read_b32 v189, v41 offset:5120
v_lshrrev_b32 v40, 2, v197
v_and_b32 v41, 3, v40
v_lshrrev_b32 v42, 2, v40
v_lshl_add_u32 v41, v42, 3, v41
s_lshl_b32 s88, s45, 3
v_xor_b32 v41, s88, v41
v_xor_b32 v41, v41, v47
v_lshlrev_b32 v41, 4, v41
s_add_u32 s88, s47, 535
v_add_u32 v40, s88, v40
v_lshl_add_u32 v245, v40, 8, v41
s_lshl_b32 s88, s46, 9
s_add_u32 s88, s88, 38912
v_lshl_add_u32 v246, v197, 2, s88
s_lshl_b32 s88, s45, 7
s_add_u32 s88, s88, 41216
v_lshl_add_u32 v247, v47, 4, s88
v_and_b32 v40, 3, v2
v_bfe_u32 v41, v2, 2, 2
v_lshl_add_u32 v42, v40, 2, v41
v_lshlrev_b32 v192, 2, v42
s_mov_b32 s88, 0xc000c000
s_mov_b32 s89, 0xc000c000
v_cndmask_b32 v193, 64, 0, s[88:89]
v_lshlrev_b32 v40, 3, v40
s_mov_b32 s88, 0x35261300
v_bfe_u32 v42, s88, v40, 8
s_movk_i32 s88, 10368
v_lshl_add_u32 v194, v42, 5, s88
s_mov_b32 s88, 0xe0d1111
v_bfe_u32 v42, s88, v40, 8
v_lshlrev_b32 v195, 5, v42
s_mov_b32 s88, 0xf000f000
s_mov_b32 s89, 0xf000f000
v_cndmask_b32 v248, 0, 31, s[88:89]
s_lshl_b32 s88, s45, 3
s_add_u32 s88, s88, s46
s_lshl_b32 s88, s88, 2
v_lshl_add_u32 v196, v47, 4, s88
v_mov_b32 v198, 1840
v_mov_b32 v199, 1968
v_mov_b32 v249, 0x40000000
s_lshl_b32 s88, s46, 3
s_lshr_b32 s88, 0x35261300, s88
s_and_b32 s88, s88, 0xff
s_lshl_b32 s88, s88, 7
s_add_u32 s92, s88, 41472
v_lshl_add_u32 v232, v47, 4, s92
s_movk_i32 s88, 8960
v_mad_u32_u24 v40, v47, s88, s88
v_lshl_add_u32 v40, v197, 2, v40
v_add_u32 v233, s92, v40
s_lshl_b32 s84, s3, 8
s_add_u32 s84, s84, s2
s_lshl_b32 s84, s84, 5
s_add_u32 s84, s84, 27918336
v_mov_b32 v116, s66
v_mov_b32 v117, s67
s_mov_b64 exec, 1
s_waitcnt vmcnt(5) lgkmcnt(0)
s_barrier
buffer_store_dwordx2 v[116:117], off, s[16:19], s84 sc0 sc1
s_mov_b64 exec, -1
v_mov_b32 v40, 0
v_mov_b32 v41, 0
v_mov_b32 v42, 0
v_mov_b32 v43, 0
s_lshl_b32 s89, s3, 12
v_lshl_add_u32 v47, v2, 4, s89
ds_write_b128 v47, v[40:43] offset:0
ds_write_b128 v47, v[40:43] offset:1024
ds_write_b128 v47, v[40:43] offset:2048
ds_write_b128 v47, v[40:43] offset:3072
s_branch L_sg2
L_exp2:
v_add_u32 v12, 16, v12
v_add_u32 v11, 64, v11
L_exp:
s_lshl_b32 s83, s51, 2
L_expl:
v_cmpx_lt_u32 vcc, v12, v10
s_cbranch_execz L_expd
v_min_u32 v7, s83, v11
v_add_u32 v7, s52, v7
ds_write_b32 v7, v9 offset:41472
v_add_u32 v12, 2, v12
v_add_u32 v11, 8, v11
s_branch L_expl
.p2align 12
L_t2:
s_branch L_tb2
s_nop 0
L_sg2:
v_mov_b32 v45, s35
v_mov_b32 v46, 1
v_lshlrev_b32 v44, 4, v2
s_movk_i32 s90, 0x1000
s_waitcnt vmcnt(1)
L_rck:
v_xor_b32 v80, s12, v80
v_xor_b32 v81, s13, v81
v_and_or_b32 v6, v80, s14, v81
v_xor_b32 v84, s12, v84
v_xor_b32 v85, s13, v85
v_and_or_b32 v7, v84, s14, v85
v_xor_b32 v88, s12, v88
v_xor_b32 v89, s13, v89
v_and_or_b32 v8, v88, s14, v89
v_xor_b32 v92, s12, v92
v_xor_b32 v93, s13, v93
v_and_or_b32 v9, v92, s14, v93
v_cmp_gt_u32 s[82:83], s90, v6
v_cmp_gt_u32 s[84:85], s90, v7
v_cmp_gt_u32 s[86:87], s90, v8
v_cmp_gt_u32 vcc, s90, v9
s_xor_b64 s[82:83], s[82:83], s[72:73]
s_xor_b64 s[84:85], s[84:85], s[74:75]
s_xor_b64 s[86:87], s[86:87], s[76:77]
s_xor_b64 vcc, vcc, s[78:79]
s_or_b64 s[82:83], s[82:83], s[84:85]
s_or_b64 vcc, vcc, s[86:87]
s_or_b64 vcc, vcc, s[82:83]
s_cbranch_scc1 L_rrt
s_cmp_gt_u32 s51, 256
s_cbranch_scc1 L_5c
L_5cd:
buffer_load_dwordx2 v[118:119], v29, s[16:19], 0 offen sc1
v_lshrrev_b32 v11, 25, v80
v_lshl_add_u32 v81, v81, 5, v24
v_and_b32 v11, 60, v11
s_mov_b64 exec, s[72:73]
ds_add_rtn_u32 v6, v11, v46 offset:40960
s_mov_b64 exec, -1
v_lshrrev_b32 v12, 25, v84
v_lshl_add_u32 v85, v85, 5, v25
v_and_b32 v12, 60, v12
s_mov_b64 exec, s[74:75]
ds_add_rtn_u32 v7, v12, v46 offset:40960
s_mov_b64 exec, -1
v_lshrrev_b32 v13, 25, v88
v_lshl_add_u32 v89, v89, 5, v26
v_and_b32 v13, 60, v13
s_mov_b64 exec, s[76:77]
ds_add_rtn_u32 v8, v13, v46 offset:40960
s_mov_b64 exec, -1
v_lshrrev_b32 v14, 25, v92
v_lshl_add_u32 v93, v93, 5, v27
v_and_b32 v14, 60, v14
s_mov_b64 exec, s[78:79]
ds_add_rtn_u32 v9, v14, v46 offset:40960
s_mov_b64 exec, -1
v_mad_u32_u16 v82, v80, 6, 0
v_and_b32 v82, -4, v82
buffer_load_dwordx2 v[82:83], v82, s[40:43], 0 offen
v_mad_u32_u16 v86, v84, 6, 0
v_and_b32 v86, -4, v86
buffer_load_dwordx2 v[86:87], v86, s[40:43], 0 offen
v_mad_u32_u16 v90, v88, 6, 0
v_and_b32 v90, -4, v90
buffer_load_dwordx2 v[90:91], v90, s[40:43], 0 offen
v_mad_u32_u16 v94, v92, 6, 0
v_and_b32 v94, -4, v94
buffer_load_dwordx2 v[94:95], v94, s[40:43], 0 offen
s_cmp_gt_u32 s51, 256
s_cbranch_scc1 L_5b
L_5bd:
s_mov_b64 exec, 1
ds_or_b32 v252, v45 offset:41024
s_mov_b64 exec, -1
s_cmp_lt_u32 s3, 4
s_cbranch_scc1 L_lop
s_setprio 1
L_lop:
ds_read_b64_tr_b16 v[32:33], v30 offset:0
ds_read_b64_tr_b16 v[34:35], v30 offset:1024
ds_read_b64_tr_b16 v[36:37], v31 offset:0
ds_read_b64_tr_b16 v[38:39], v31 offset:1024
ds_read_b64_tr_b16 v[100:101], v30 offset:4096
ds_read_b64_tr_b16 v[102:103], v30 offset:5120
ds_read_b64_tr_b16 v[104:105], v31 offset:4096
ds_read_b64_tr_b16 v[106:107], v31 offset:5120
ds_read_b64_tr_b16 v[108:109], v30 offset:8192
ds_read_b64_tr_b16 v[110:111], v30 offset:9216
ds_read_b64_tr_b16 v[112:113], v31 offset:8192
ds_read_b64_tr_b16 v[114:115], v31 offset:9216
s_and_b32 s88, s2, 7
s_waitcnt lgkmcnt(8)
v_mfma_f32_32x32x16_bf16 v[48:63], v[120:123], v[32:35], 0
v_mfma_f32_32x32x16_bf16 v[64:79], v[120:123], v[36:39], 0
ds_read_b64_tr_b16 v[16:17], v30 offset:12288
ds_read_b64_tr_b16 v[18:19], v30 offset:13312
ds_read_b64_tr_b16 v[20:21], v31 offset:12288
ds_read_b64_tr_b16 v[22:23], v31 offset:13312
s_lshl_b32 s88, s88, 3
s_waitcnt lgkmcnt(8)
v_mfma_f32_32x32x16_bf16 v[48:63], v[124:127], v[100:103], v[48:63]
v_mfma_f32_32x32x16_bf16 v[64:79], v[124:127], v[104:107], v[64:79]
ds_read_b64_tr_b16 v[32:33], v30 offset:16384
ds_read_b64_tr_b16 v[34:35], v30 offset:17408
ds_read_b64_tr_b16 v[36:37], v31 offset:16384
ds_read_b64_tr_b16 v[38:39], v31 offset:17408
s_add_u32 s88, s88, s3
s_waitcnt lgkmcnt(8)
v_mfma_f32_32x32x16_bf16 v[48:63], v[128:131], v[108:111], v[48:63]
v_mfma_f32_32x32x16_bf16 v[64:79], v[128:131], v[112:115], v[64:79]
ds_read_b64_tr_b16 v[100:101], v30 offset:20480
ds_read_b64_tr_b16 v[102:103], v30 offset:21504
ds_read_b64_tr_b16 v[104:105], v31 offset:20480
ds_read_b64_tr_b16 v[106:107], v31 offset:21504
s_lshl_b32 s88, s88, 10
s_waitcnt lgkmcnt(8)
v_mfma_f32_32x32x16_bf16 v[48:63], v[132:135], v[16:19], v[48:63]
v_mfma_f32_32x32x16_bf16 v[64:79], v[132:135], v[20:23], v[64:79]
ds_read_b64_tr_b16 v[108:109], v30 offset:24576
ds_read_b64_tr_b16 v[110:111], v30 offset:25600
ds_read_b64_tr_b16 v[112:113], v31 offset:24576
ds_read_b64_tr_b16 v[114:115], v31 offset:25600
v_and_b32 v250, 31, v2
s_waitcnt lgkmcnt(8)
v_mfma_f32_32x32x16_bf16 v[48:63], v[136:139], v[32:35], v[48:63]
v_mfma_f32_32x32x16_bf16 v[64:79], v[136:139], v[36:39], v[64:79]
ds_read_b64_tr_b16 v[16:17], v30 offset:28672
ds_read_b64_tr_b16 v[18:19], v30 offset:29696
ds_read_b64_tr_b16 v[20:21], v31 offset:28672
ds_read_b64_tr_b16 v[22:23], v31 offset:29696
s_add_u32 s88, s88, 27918336
s_waitcnt lgkmcnt(8)
v_mfma_f32_32x32x16_bf16 v[48:63], v[140:143], v[100:103], v[48:63]
v_mfma_f32_32x32x16_bf16 v[64:79], v[140:143], v[104:107], v[64:79]
v_lshl_add_u32 v250, v250, 5, s88
s_waitcnt lgkmcnt(4)
v_mfma_f32_32x32x16_bf16 v[48:63], v[144:147], v[108:111], v[48:63]
v_mfma_f32_32x32x16_bf16 v[64:79], v[144:147], v[112:115], v[64:79]
s_waitcnt lgkmcnt(0)
v_mfma_f32_32x32x16_bf16 v[48:63], v[148:151], v[16:19], v[48:63]
v_mfma_f32_32x32x16_bf16 v[64:79], v[148:151], v[20:23], v[64:79]
s_nop 10
v_pk_mul_f32 v[48:49], v[48:49], s[64:65]
v_pk_mul_f32 v[50:51], v[50:51], s[64:65]
v_pk_mul_f32 v[52:53], v[52:53], s[64:65]
v_pk_mul_f32 v[54:55], v[54:55], s[64:65]
v_pk_mul_f32 v[56:57], v[56:57], s[64:65]
v_pk_mul_f32 v[58:59], v[58:59], s[64:65]
v_pk_mul_f32 v[60:61], v[60:61], s[64:65]
v_pk_mul_f32 v[62:63], v[62:63], s[64:65]
v_cvt_pk_bf16_f32 v160, v48, v49
v_cvt_pk_bf16_f32 v161, v50, v51
v_cvt_pk_bf16_f32 v162, v52, v53
v_cvt_pk_bf16_f32 v163, v54, v55
v_cvt_pk_bf16_f32 v168, v56, v57
v_cvt_pk_bf16_f32 v169, v58, v59
v_cvt_pk_bf16_f32 v170, v60, v61
v_cvt_pk_bf16_f32 v171, v62, v63
v_pk_mul_f32 v[64:65], v[64:65], s[64:65]
v_pk_mul_f32 v[66:67], v[66:67], s[64:65]
v_pk_mul_f32 v[68:69], v[68:69], s[64:65]
v_pk_mul_f32 v[70:71], v[70:71], s[64:65]
v_pk_mul_f32 v[72:73], v[72:73], s[64:65]
v_pk_mul_f32 v[74:75], v[74:75], s[64:65]
v_pk_mul_f32 v[76:77], v[76:77], s[64:65]
v_pk_mul_f32 v[78:79], v[78:79], s[64:65]
v_cvt_pk_bf16_f32 v164, v64, v65
v_cvt_pk_bf16_f32 v165, v66, v67
v_cvt_pk_bf16_f32 v166, v68, v69
v_cvt_pk_bf16_f32 v167, v70, v71
v_cvt_pk_bf16_f32 v172, v72, v73
v_cvt_pk_bf16_f32 v173, v74, v75
v_cvt_pk_bf16_f32 v174, v76, v77
v_cvt_pk_bf16_f32 v175, v78, v79
s_waitcnt vmcnt(4)
v_cmp_ne_u64 vcc, s[66:67], v[118:119]
s_cbranch_vccnz L_wfp
L_wfd:
v_lshlrev_b32_sdwa v100, 4, v80 dst_sel:DWORD dst_unused:UNUSED_PAD src0_sel:DWORD src1_sel:BYTE_3
ds_read_b128 v[100:103], v100 offset:36864
v_bfe_u32 v16, v80, 16, 12
v_mad_u32_u16 v80, v80, 8, 0
v_xor_b32 v24, 128, v16
v_add_u32 v32, 16, v81
v_lshlrev_b32_sdwa v104, 4, v84 dst_sel:DWORD dst_unused:UNUSED_PAD src0_sel:DWORD src1_sel:BYTE_3
ds_read_b128 v[104:107], v104 offset:36864
v_bfe_u32 v17, v84, 16, 12
v_mad_u32_u16 v84, v84, 8, 0
v_xor_b32 v25, 128, v17
v_add_u32 v33, 16, v85
v_lshlrev_b32_sdwa v108, 4, v88 dst_sel:DWORD dst_unused:UNUSED_PAD src0_sel:DWORD src1_sel:BYTE_3
ds_read_b128 v[108:111], v108 offset:36864
v_bfe_u32 v18, v88, 16, 12
v_mad_u32_u16 v88, v88, 8, 0
v_xor_b32 v26, 128, v18
v_add_u32 v34, 16, v89
v_lshlrev_b32_sdwa v112, 4, v92 dst_sel:DWORD dst_unused:UNUSED_PAD src0_sel:DWORD src1_sel:BYTE_3
ds_read_b128 v[112:115], v112 offset:36864
v_bfe_u32 v19, v92, 16, 12
v_mad_u32_u16 v92, v92, 8, 0
v_xor_b32 v27, 128, v19
v_add_u32 v35, 16, v93
s_cmp_gt_u32 s51, 256
s_cbranch_scc1 L_5p
L_5pd:
s_waitcnt lgkmcnt(0)
s_barrier
ds_read_b32 v21, v192 offset:40960
ds_read_b32 v22, v252 offset:41024
buffer_load_dwordx2 v[78:79], v250, s[16:19], 0 offen sc1
s_lshl_b32 s84, s45, 9
s_add_u32 s84, s84, 27889664
buffer_load_dword v238, v1, s[16:19], s84 offen sc1
buffer_load_dword v243, v1, s[16:19], s84 offen offset:256 sc1
s_lshl_b32 s84, s45, 11
s_add_u32 s84, s84, 27885568
buffer_load_dwordx4 v[152:155], v44, s[16:19], s84 offen sc1
buffer_load_dwordx4 v[156:159], v44, s[16:19], s84 offen offset:1024 sc1
s_mov_b32 m0, 41216
s_mov_b32 s82, 27890688
buffer_load_dword v1, s[16:19], s82 offen sc1 lds
s_lshl_b32 s85, s3, 12
s_add_u32 m0, s85, 104192
s_add_u32 s82, s85, 27820032
buffer_load_dwordx4 v44, s[16:19], s82 offen offset:0 sc1 lds
buffer_load_dwordx4 v44, s[16:19], s82 offen offset:1024 sc1 lds
buffer_load_dwordx4 v44, s[16:19], s82 offen offset:2048 sc1 lds
buffer_load_dwordx4 v44, s[16:19], s82 offen offset:3072 sc1 lds
v_and_b32 v234, 12, v11
v_lshl_add_u32 v234, v234, 8, v6
v_cmp_gt_u32 vcc, 96, v234
s_nop 1
v_cndmask_b32 v251, v249, v81, vcc
buffer_load_dword v236, v251, s[24:27], 0 offen
v_and_b32 v235, 12, v12
v_lshl_add_u32 v235, v235, 8, v7
v_cmp_gt_u32 vcc, 96, v235
s_nop 1
v_cndmask_b32 v251, v249, v85, vcc
buffer_load_dword v236, v251, s[24:27], 0 offen
v_and_b32 v237, 12, v13
v_lshl_add_u32 v237, v237, 8, v8
v_cmp_gt_u32 vcc, 96, v237
s_nop 1
v_cndmask_b32 v251, v249, v89, vcc
buffer_load_dword v236, v251, s[24:27], 0 offen
s_add_u32 s83, s46, 4
s_add_u32 s84, s46, 8
s_add_u32 s85, s46, 12
s_waitcnt lgkmcnt(1)
v_max_u32 v23, v21, v193
v_sub_u32 v31, v194, v23
v_sub_u32 v38, v23, v21
v_add_u32_dpp v29, v23, v23 row_shr:4 row_mask:0xf bank_mask:0xf bound_ctrl:1
v_add_u32 v37, v31, v21
v_lshlrev_b32 v250, 3, v2
v_add_u32_dpp v29, v29, v29 row_shr:8 row_mask:0xf bank_mask:0xf bound_ctrl:1
v_add_u32 v30, v29, v31
ds_write_b32 v192, v30 offset:41088
ds_read_b32 v40, v11 offset:41088
ds_read_b32 v41, v12 offset:41088
ds_read_b32 v42, v13 offset:41088
ds_read_b32 v43, v14 offset:41088
v_cmp_gt_u32 vcc, v29, v195
v_sub_u32 v39, 0, v29
v_add_u32 v37, v37, v29
v_and_b32 v39, v248, v39
v_add_u32 v38, v38, v39
s_cbranch_vccnz L_retry
ds_bpermute_b32 v45, v196, v37
ds_bpermute_b32 v46, v196, v38
v_readlane_b32 s53, v29, s46
v_readlane_b32 s54, v29, s83
v_readlane_b32 s55, v29, s84
v_readlane_b32 s57, v29, s85
s_xor_b32 s85, s85, 2
v_readlane_b32 s29, v29, s85
s_waitcnt vmcnt(13)
v_lshlrev_b32 v48, 1, v80
v_alignbit_b32 v82, v83, v82, v48
v_bfe_u32 v83, v83, v48, 16
v_lshlrev_b32 v49, 1, v84
v_alignbit_b32 v86, v87, v86, v49
v_bfe_u32 v87, v87, v49, 16
v_lshlrev_b32 v50, 1, v88
v_alignbit_b32 v90, v91, v90, v50
v_bfe_u32 v91, v91, v50, 16
v_lshlrev_b32 v51, 1, v92
v_alignbit_b32 v94, v95, v94, v51
v_bfe_u32 v95, v95, v51, 16
v_dot2_f32_bf16 v100, v82, s69, v100
v_dot2_f32_bf16 v101, v82, s70, v101
v_dot2_f32_bf16 v102, v83, s69, v102
v_dot2_f32_bf16 v104, v86, s69, v104
v_dot2_f32_bf16 v105, v86, s70, v105
v_dot2_f32_bf16 v106, v87, s69, v106
v_dot2_f32_bf16 v108, v90, s69, v108
v_dot2_f32_bf16 v109, v90, s70, v109
v_dot2_f32_bf16 v110, v91, s69, v110
v_dot2_f32_bf16 v112, v94, s69, v112
v_dot2_f32_bf16 v113, v94, s70, v113
v_dot2_f32_bf16 v114, v95, s69, v114
v_cvt_pk_bf16_f32 v101, v102, v101
v_cvt_pk_bf16_f32 v102, v100, 0
v_cvt_pk_bf16_f32 v105, v106, v105
v_cvt_pk_bf16_f32 v106, v104, 0
v_cvt_pk_bf16_f32 v109, v110, v109
v_cvt_pk_bf16_f32 v110, v108, 0
v_cvt_pk_bf16_f32 v113, v114, v113
v_cvt_pk_bf16_f32 v114, v112, 0
v_dot2_f32_bf16 v103, v101, v101, 0
v_dot2_f32_bf16 v107, v105, v105, 0
v_dot2_f32_bf16 v111, v109, v109, 0
v_dot2_f32_bf16 v115, v113, v113, 0
v_dot2_f32_bf16 v103, v102, v102, v103
v_dot2_f32_bf16 v107, v106, v106, v107
v_dot2_f32_bf16 v111, v110, v110, v111
v_dot2_f32_bf16 v115, v114, v114, v115
v_cvt_pk_bf16_f32 v100, v100, v103
v_cvt_pk_bf16_f32 v104, v104, v107
v_cvt_pk_bf16_f32 v108, v108, v111
v_cvt_pk_bf16_f32 v112, v112, v115
s_waitcnt lgkmcnt(2)
v_add_lshl_u32 v40, v40, v6, 2
v_add_lshl_u32 v41, v41, v7, 2
v_add_lshl_u32 v42, v42, v8, 2
v_add_lshl_u32 v43, v43, v9, 2
s_mov_b64 exec, s[72:73]
ds_write_b32 v40, v80
ds_write2st64_b32 v40, v100, v101 offset0:35 offset1:70
ds_write2st64_b32 v40, v16, v24 offset0:105 offset1:140
ds_write2st64_b32 v40, v81, v32 offset0:175 offset1:210
s_mov_b64 exec, s[74:75]
ds_write_b32 v41, v84
ds_write2st64_b32 v41, v104, v105 offset0:35 offset1:70
ds_write2st64_b32 v41, v17, v25 offset0:105 offset1:140
ds_write2st64_b32 v41, v85, v33 offset0:175 offset1:210
s_waitcnt lgkmcnt(8)
s_mov_b64 exec, s[76:77]
ds_write_b32 v42, v88
ds_write2st64_b32 v42, v108, v109 offset0:35 offset1:70
ds_write2st64_b32 v42, v18, v26 offset0:105 offset1:140
ds_write2st64_b32 v42, v89, v34 offset0:175 offset1:210
s_mov_b64 exec, s[78:79]
ds_write_b32 v43, v92
ds_write2st64_b32 v43, v112, v113 offset0:35 offset1:70
ds_write2st64_b32 v43, v19, v27 offset0:105 offset1:140
ds_write2st64_b32 v43, v93, v35 offset0:175 offset1:210
s_mov_b64 exec, -1
s_cmp_gt_u32 s51, 256
s_cbranch_scc1 L_5d
L_5dd:
s_add_u32 s57, s57, 31
s_lshr_b32 s57, s57, 5
s_sub_u32 s53, s53, 1
s_lshr_b32 s53, s53, 5
s_sub_u32 s54, s54, 1
s_lshr_b32 s54, s54, 5
s_sub_u32 s55, s55, 1
s_lshr_b32 s55, s55, 5
s_sub_u32 s56, s57, s55
s_sub_u32 s56, s56, 2
s_sub_u32 s55, s55, s54
s_sub_u32 s55, s55, 1
s_sub_u32 s54, s54, s53
s_sub_u32 s54, s54, 1
s_mul_i32 s83, s57, 864
s_mul_i32 s29, s29, 7
s_sub_i32 s83, s83, s29
s_sub_i32 s83, s83, 816
s_ashr_i32 s83, s83, 9
s_sub_i32 s83, s83, s53
s_sub_i32 s83, s83, 1
s_cmp_lt_u32 s3, 4
s_cselect_b32 s83, 0, s83
s_cmp_gt_i32 s83, 0
s_cselect_b32 s93, 1, 0
s_cselect_b32 s83, s83, 9999
s_sub_i32 s29, s54, s83
s_cmp_ge_i32 s29, 0
s_cselect_b32 s31, 0, -9
s_cselect_b32 s83, s83, 1
s_cselect_b32 s84, 0, s54
s_add_i32 s54, s83, s84
s_sub_i32 s54, s54, 1
s_add_u32 s83, s57, s45
s_lshl_b32 s84, s83, 7
s_add_u32 s82, s92, s84
s_and_b32 s83, s83, 1
s_lshl_b32 s83, s83, 8
s_add_u32 s83, s83, 870400
v_add_u32 v34, s82, v1
v_add_u32 v35, s83, v250
v_add_lshl_u32 v45, v45, v197, 2
s_mov_b64 exec, s[60:61]
ds_write_b32 v34, v35
s_mov_b64 exec, -1
v_cmp_lt_u32 s[86:87], 32, v46
v_cmpx_gt_u32 vcc, v46, v197
ds_write_b32 v45, v252
ds_write2st64_b32 v45, v252, v252 offset0:35 offset1:70
ds_write2st64_b32 v45, v198, v199 offset0:105 offset1:140
ds_write2st64_b32 v45, v249, v249 offset0:175 offset1:210
s_cmp_lg_u64 s[86:87], 0
s_cbranch_scc1 L_padl
L_padd:
s_mov_b64 exec, -1
s_nop 1
v_readfirstlane_b32 s35, v22
s_waitcnt vmcnt(3)
v_cmp_ne_u64 vcc, s[66:67], v[78:79]
s_cbranch_vccnz L_poll
L_polld:
s_waitcnt lgkmcnt(0)
s_barrier
ds_read_b32 v6, v233 offset:35840
ds_read_b128 v[16:19], v232 offset:0
ds_read_b128 v[20:23], v232 offset:32
ds_read_b128 v[24:27], v232 offset:64
ds_read_b128 v[28:31], v232 offset:96
ds_read_b32 v7, v233 offset:35968
ds_read_b128 v[32:35], v232 offset:128
ds_read_b128 v[36:39], v232 offset:160
ds_read_b128 v[40:43], v232 offset:192
ds_read_b128 v[44:47], v232 offset:224
ds_read2st64_b32 v[234:235], v233 offset1:70
v_bfi_b32 v163, s68, v238, v163
v_bfi_b32 v171, s68, v238, v171
v_bfi_b32 v167, s68, v243, v167
v_bfi_b32 v175, s68, v243, v175
s_waitcnt lgkmcnt(10)
buffer_load_dwordx4 v[192:195], v6, s[24:27], 0 offen
s_waitcnt lgkmcnt(9)
buffer_load_dword v16, v16, s[4:7], 0 offen sc1
buffer_load_dword v17, v17, s[4:7], 0 offen sc1
buffer_load_dword v18, v18, s[4:7], 0 offen sc1
buffer_load_dword v19, v19, s[4:7], 0 offen sc1
s_waitcnt lgkmcnt(8)
buffer_load_dword v20, v20, s[4:7], 0 offen sc1
buffer_load_dword v21, v21, s[4:7], 0 offen sc1
buffer_load_dword v22, v22, s[4:7], 0 offen sc1
buffer_load_dword v23, v23, s[4:7], 0 offen sc1
s_waitcnt lgkmcnt(7)
buffer_load_dword v24, v24, s[4:7], 0 offen sc1
buffer_load_dword v25, v25, s[4:7], 0 offen sc1
buffer_load_dword v26, v26, s[4:7], 0 offen sc1
buffer_load_dword v27, v27, s[4:7], 0 offen sc1
s_waitcnt lgkmcnt(6)
buffer_load_dword v28, v28, s[4:7], 0 offen sc1
buffer_load_dword v29, v29, s[4:7], 0 offen sc1
buffer_load_dword v30, v30, s[4:7], 0 offen sc1
buffer_load_dword v31, v31, s[4:7], 0 offen sc1
s_waitcnt lgkmcnt(0)
buffer_load_dwordx4 v[248:251], v7, s[24:27], 0 offen
ds_read_b128 v[196:199], v235 offset:32768
s_lshl_b32 s82, s45, 14
s_add_u32 s82, s82, 104192
v_lshl_add_u32 v13, v2, 4, s82
v_add_u32 v233, 128, v233
ds_read_b128 v[48:51], v13 offset:0
ds_read_b128 v[52:55], v13 offset:1024
ds_read_b128 v[56:59], v13 offset:2048
ds_read_b128 v[60:63], v13 offset:3072
ds_read_b128 v[64:67], v13 offset:4096
ds_read_b128 v[68:71], v13 offset:5120
ds_read_b128 v[72:75], v13 offset:6144
ds_read_b128 v[76:79], v13 offset:7168
ds_read_b128 v[80:83], v13 offset:8192
ds_read_b128 v[84:87], v13 offset:9216
ds_read_b128 v[88:91], v13 offset:10240
ds_read_b128 v[92:95], v13 offset:11264
buffer_load_dword v32, v32, s[4:7], 0 offen sc1
buffer_load_dword v33, v33, s[4:7], 0 offen sc1
buffer_load_dword v34, v34, s[4:7], 0 offen sc1
buffer_load_dword v35, v35, s[4:7], 0 offen sc1
buffer_load_dword v36, v36, s[4:7], 0 offen sc1
buffer_load_dword v37, v37, s[4:7], 0 offen sc1
buffer_load_dword v38, v38, s[4:7], 0 offen sc1
buffer_load_dword v39, v39, s[4:7], 0 offen sc1
buffer_load_dword v40, v40, s[4:7], 0 offen sc1
buffer_load_dword v41, v41, s[4:7], 0 offen sc1
buffer_load_dword v42, v42, s[4:7], 0 offen sc1
buffer_load_dword v43, v43, s[4:7], 0 offen sc1
buffer_load_dword v44, v44, s[4:7], 0 offen sc1
buffer_load_dword v45, v45, s[4:7], 0 offen sc1
buffer_load_dword v46, v46, s[4:7], 0 offen sc1
buffer_load_dword v47, v47, s[4:7], 0 offen sc1
v_mov_b32 v112, 0
v_mov_b32 v113, 0
v_mov_b32 v114, 0
v_mov_b32 v115, 0
v_mov_b32 v116, 0
v_mov_b32 v117, 0
v_mov_b32 v118, 0
v_mov_b32 v119, 0
s_cmp_eq_u32 s50, 0
s_waitcnt lgkmcnt(10)
v_bfi_b32 v199, s68, v234, v199
ds_read_b128 v[96:99], v13 offset:12288
ds_read_b128 v[100:103], v13 offset:13312
ds_read_b128 v[104:107], v13 offset:14336
ds_read_b128 v[108:111], v13 offset:15360
s_cbranch_scc1 L_noh
s_waitcnt lgkmcnt(14)
v_mfma_f32_32x32x16_bf16 v[200:215], v[120:123], v[48:51], 0
v_mfma_f32_32x32x16_bf16 v[216:231], v[120:123], v[52:55], 0
s_waitcnt lgkmcnt(12)
v_mfma_f32_32x32x16_bf16 v[200:215], v[124:127], v[56:59], v[200:215]
v_mfma_f32_32x32x16_bf16 v[216:231], v[124:127], v[60:63], v[216:231]
s_waitcnt lgkmcnt(10)
v_mfma_f32_32x32x16_bf16 v[200:215], v[128:131], v[64:67], v[200:215]
v_mfma_f32_32x32x16_bf16 v[216:231], v[128:131], v[68:71], v[216:231]
s_waitcnt lgkmcnt(8)
v_mfma_f32_32x32x16_bf16 v[200:215], v[132:135], v[72:75], v[200:215]
v_mfma_f32_32x32x16_bf16 v[216:231], v[132:135], v[76:79], v[216:231]
s_waitcnt lgkmcnt(6)
v_mfma_f32_32x32x16_bf16 v[200:215], v[136:139], v[80:83], v[200:215]
v_mfma_f32_32x32x16_bf16 v[216:231], v[136:139], v[84:87], v[216:231]
s_waitcnt lgkmcnt(4)
v_mfma_f32_32x32x16_bf16 v[200:215], v[140:143], v[88:91], v[200:215]
v_mfma_f32_32x32x16_bf16 v[216:231], v[140:143], v[92:95], v[216:231]
s_waitcnt lgkmcnt(2)
v_mfma_f32_32x32x16_bf16 v[200:215], v[144:147], v[96:99], v[200:215]
v_mfma_f32_32x32x16_bf16 v[216:231], v[144:147], v[100:103], v[216:231]
s_waitcnt lgkmcnt(0)
v_mfma_f32_32x32x16_bf16 v[200:215], v[148:151], v[104:107], v[200:215]
v_mfma_f32_32x32x16_bf16 v[216:231], v[148:151], v[108:111], v[216:231]
L_noh:
s_waitcnt lgkmcnt(0)
v_mfma_f32_32x32x16_bf16 v[120:135], v[252:255], v[252:255], 0
v_mfma_f32_32x32x16_bf16 v[136:151], v[252:255], v[252:255], 0
s_cbranch_scc1 L_noh2
s_nop 6
v_pk_mul_f32 v[200:201], v[200:201], s[64:65]
v_pk_mul_f32 v[202:203], v[202:203], s[64:65]
v_pk_mul_f32 v[204:205], v[204:205], s[64:65]
v_pk_mul_f32 v[206:207], v[206:207], s[64:65]
v_pk_mul_f32 v[208:209], v[208:209], s[64:65]
v_pk_mul_f32 v[210:211], v[210:211], s[64:65]
v_pk_mul_f32 v[212:213], v[212:213], s[64:65]
v_pk_mul_f32 v[214:215], v[214:215], s[64:65]
v_pk_mul_f32 v[216:217], v[216:217], s[64:65]
v_pk_mul_f32 v[218:219], v[218:219], s[64:65]
v_pk_mul_f32 v[220:221], v[220:221], s[64:65]
v_pk_mul_f32 v[222:223], v[222:223], s[64:65]
v_pk_mul_f32 v[224:225], v[224:225], s[64:65]
v_pk_mul_f32 v[226:227], v[226:227], s[64:65]
v_pk_mul_f32 v[228:229], v[228:229], s[64:65]
v_pk_mul_f32 v[230:231], v[230:231], s[64:65]
L_noh2:
v_mov_b32 v9, 0x3f80
v_cndmask_b32 v8, 0, v9, s[60:61]
v_mov_b32 v9, 0
v_mov_b32 v10, 0
v_mov_b32 v11, 0
s_waitcnt vmcnt(17)
v_lshlrev_b32 v48, 16, v16
v_lshlrev_b32 v49, 16, v17
v_lshlrev_b32 v50, 16, v18
v_lshlrev_b32 v51, 16, v19
v_lshlrev_b32 v52, 16, v20
v_lshlrev_b32 v53, 16, v21
v_lshlrev_b32 v54, 16, v22
v_lshlrev_b32 v55, 16, v23
v_lshlrev_b32 v56, 16, v24
v_lshlrev_b32 v57, 16, v25
v_lshlrev_b32 v58, 16, v26
v_lshlrev_b32 v59, 16, v27
v_lshlrev_b32 v60, 16, v28
v_lshlrev_b32 v61, 16, v29
v_lshlrev_b32 v62, 16, v30
v_lshlrev_b32 v63, 16, v31
s_nop 1
v_mfma_f32_32x32x16_bf16 v[48:63], v[196:199], v[160:163], v[48:63]
v_mfma_f32_32x32x16_bf16 v[48:63], v[192:195], v[152:155], v[48:63]
s_nop 7
s_nop 3
s_branch L_sg3
.p2align 12
L_t3:
s_branch L_tb3
s_nop 0
L_sg3:
L_l0:
v_exp_f32_e64 v80, v48
ds_read2st64_b32 v[236:237], v233 offset1:70
ds_read_b32 v238, v233 offset:35968
v_mfma_f32_32x32x16_bf16 v[64:79], v[192:195], v[156:159], v[16:31]
v_exp_f32 v81, v49
v_exp_f32 v82, v50
v_exp_f32 v83, v51
v_exp_f32 v84, v52
v_mfma_f32_32x32x16_bf16 v[64:79], v[196:199], v[164:167], v[64:79]
v_exp_f32_e64 v85, v53
v_exp_f32 v86, v54
s_waitcnt lgkmcnt(0)
ds_read_b128 v[196:199], v237 offset:32768
ds_read_b128 v[16:19], v232 offset:256
ds_read_b128 v[20:23], v232 offset:288
ds_read_b128 v[24:27], v232 offset:320
ds_read_b128 v[28:31], v232 offset:352
v_exp_f32 v87, v55
v_exp_f32 v88, v56
v_exp_f32_e64 v89, v57
v_mfma_f32_32x32x16_bf16 v[120:135], v[96:99], v[112:115], v[120:135]
v_exp_f32 v90, v58
v_exp_f32 v91, v59
v_exp_f32 v92, v60
v_exp_f32 v93, v61
v_exp_f32_e64 v94, v62
v_exp_f32 v95, v63
buffer_load_dwordx4 v[192:195], v238, s[24:27], 0 offen
s_waitcnt lgkmcnt(0)
v_mfma_f32_32x32x16_bf16 v[80:95], v[8:11], v[8:11], v[80:95]
buffer_load_dword v16, v16, s[4:7], 0 offen sc1
buffer_load_dword v17, v17, s[4:7], 0 offen sc1
buffer_load_dword v18, v18, s[4:7], 0 offen sc1
buffer_load_dword v19, v19, s[4:7], 0 offen sc1
buffer_load_dword v20, v20, s[4:7], 0 offen sc1
buffer_load_dword v21, v21, s[4:7], 0 offen sc1
v_mfma_f32_32x32x16_bf16 v[120:135], v[100:103], v[116:119], v[120:135]
ds_write_b16 v239, v252
ds_write_b16 v239, v252 offset:64
s_nop 2
v_rcp_f32 v80, v80
v_rcp_f32_e64 v81, v81
v_mfma_f32_32x32x16_bf16 v[136:151], v[104:107], v[112:115], v[136:151]
v_rcp_f32 v82, v82
v_rcp_f32 v83, v83
v_rcp_f32 v84, v84
v_rcp_f32 v85, v85
v_rcp_f32_e64 v86, v86
v_mfma_f32_32x32x16_bf16 v[136:151], v[108:111], v[116:119], v[136:151]
v_rcp_f32 v87, v87
v_rcp_f32 v88, v88
v_rcp_f32 v89, v89
v_rcp_f32 v90, v90
v_rcp_f32 v91, v91
v_rcp_f32 v92, v92
v_rcp_f32 v93, v93
v_rcp_f32 v94, v94
v_rcp_f32_e64 v95, v95
v_pk_mul_f32 v[80:81], v[80:81], v[48:49]
v_pk_mul_f32 v[82:83], v[82:83], v[50:51]
v_pk_mul_f32 v[84:85], v[84:85], v[52:53]
v_pk_mul_f32 v[86:87], v[86:87], v[54:55]
v_pk_mul_f32 v[88:89], v[88:89], v[56:57]
v_pk_mul_f32 v[90:91], v[90:91], v[58:59]
v_pk_mul_f32 v[92:93], v[92:93], v[60:61]
v_pk_mul_f32 v[94:95], v[94:95], v[62:63]
v_bfi_b32 v199, s68, v236, v199
v_cvt_pk_bf16_f32 v96, v80, v81
v_cvt_pk_bf16_f32 v97, v82, v83
v_cvt_pk_bf16_f32 v98, v84, v85
v_cvt_pk_bf16_f32 v99, v86, v87
v_cvt_pk_bf16_f32 v100, v88, v89
v_cvt_pk_bf16_f32 v101, v90, v91
v_cvt_pk_bf16_f32 v102, v92, v93
v_cvt_pk_bf16_f32 v103, v94, v95
v_exp_f32 v80, v64
v_exp_f32 v81, v65
v_exp_f32 v82, v66
v_exp_f32 v83, v67
v_exp_f32 v84, v68
v_exp_f32 v85, v69
v_exp_f32 v86, v70
v_exp_f32 v87, v71
s_waitcnt vmcnt(17)
v_lshlrev_b32 v48, 16, v32
v_lshlrev_b32 v49, 16, v33
v_lshlrev_b32 v50, 16, v34
v_lshlrev_b32 v51, 16, v35
v_lshlrev_b32 v52, 16, v36
v_lshlrev_b32 v53, 16, v37
v_exp_f32 v88, v72
v_exp_f32 v89, v73
v_exp_f32 v90, v74
v_exp_f32 v91, v75
v_exp_f32 v92, v76
v_exp_f32 v93, v77
v_exp_f32 v94, v78
v_exp_f32 v95, v79
v_xor_b32 v239, v235, v240
v_cndmask_b32 v243, v234, 1.0, s[60:61]
v_mfma_f32_32x32x16_bf16 v[80:95], v[8:11], v[8:11], v[80:95]
ds_write_b16 v239, v234 offset:64
ds_write_b16_d16_hi v239, v243
ds_read_b128 v[112:115], v241
ds_read_b128 v[116:119], v242
buffer_load_dword v22, v22, s[4:7], 0 offen sc1
buffer_load_dword v23, v23, s[4:7], 0 offen sc1
buffer_load_dword v24, v24, s[4:7], 0 offen sc1
buffer_load_dword v25, v25, s[4:7], 0 offen sc1
buffer_load_dword v26, v26, s[4:7], 0 offen sc1
buffer_load_dword v27, v27, s[4:7], 0 offen sc1
buffer_load_dword v28, v28, s[4:7], 0 offen sc1
buffer_load_dword v29, v29, s[4:7], 0 offen sc1
buffer_load_dword v30, v30, s[4:7], 0 offen sc1
buffer_load_dword v31, v31, s[4:7], 0 offen sc1
v_add_u32 v233, 128, v233
s_sub_u32 s53, s53, 1
s_waitcnt vmcnt(17)
v_lshlrev_b32 v54, 16, v38
v_lshlrev_b32 v55, 16, v39
v_lshlrev_b32 v56, 16, v40
v_lshlrev_b32 v57, 16, v41
v_lshlrev_b32 v58, 16, v42
v_lshlrev_b32 v59, 16, v43
v_lshlrev_b32 v60, 16, v44
v_lshlrev_b32 v61, 16, v45
v_lshlrev_b32 v62, 16, v46
v_lshlrev_b32 v63, 16, v47
v_rcp_f32 v80, v80
v_rcp_f32 v81, v81
v_mfma_f32_32x32x16_bf16 v[48:63], v[196:199], v[160:163], v[48:63]
v_rcp_f32 v82, v82
v_rcp_f32 v83, v83
v_rcp_f32 v84, v84
v_rcp_f32 v85, v85
v_rcp_f32_e64 v86, v86
v_mfma_f32_32x32x16_bf16 v[48:63], v[248:251], v[152:155], v[48:63]
v_rcp_f32 v87, v87
v_rcp_f32 v88, v88
v_rcp_f32 v89, v89
v_rcp_f32 v90, v90
v_rcp_f32 v91, v91
v_rcp_f32 v92, v92
v_rcp_f32 v93, v93
v_rcp_f32 v94, v94
v_rcp_f32_e64 v95, v95
v_pk_mul_f32 v[80:81], v[80:81], v[64:65]
v_pk_mul_f32 v[82:83], v[82:83], v[66:67]
v_pk_mul_f32 v[84:85], v[84:85], v[68:69]
v_pk_mul_f32 v[86:87], v[86:87], v[70:71]
v_pk_mul_f32 v[88:89], v[88:89], v[72:73]
v_pk_mul_f32 v[90:91], v[90:91], v[74:75]
v_pk_mul_f32 v[92:93], v[92:93], v[76:77]
v_pk_mul_f32 v[94:95], v[94:95], v[78:79]
v_cvt_pk_bf16_f32 v104, v80, v81
v_cvt_pk_bf16_f32 v105, v82, v83
v_cvt_pk_bf16_f32 v106, v84, v85
v_cvt_pk_bf16_f32 v107, v86, v87
v_cvt_pk_bf16_f32 v108, v88, v89
v_cvt_pk_bf16_f32 v109, v90, v91
v_cvt_pk_bf16_f32 v110, v92, v93
v_cvt_pk_bf16_f32 v111, v94, v95
s_cbranch_scc1 L_ev0
L_l1:
v_exp_f32 v80, v48
ds_read2st64_b32 v[234:235], v233 offset1:70
ds_read_b32 v238, v233 offset:35968
v_mfma_f32_32x32x16_bf16 v[64:79], v[248:251], v[156:159], v[32:47]
v_exp_f32 v81, v49
v_exp_f32 v82, v50
v_exp_f32 v83, v51
v_exp_f32 v84, v52
v_mfma_f32_32x32x16_bf16 v[64:79], v[196:199], v[164:167], v[64:79]
v_exp_f32_e64 v85, v53
v_exp_f32 v86, v54
s_waitcnt lgkmcnt(0)
ds_read_b128 v[196:199], v235 offset:32768
ds_read_b128 v[32:35], v232 offset:384
ds_read_b128 v[36:39], v232 offset:416
ds_read_b128 v[40:43], v232 offset:448
ds_read_b128 v[44:47], v232 offset:480
v_exp_f32 v87, v55
v_exp_f32 v88, v56
v_exp_f32_e64 v89, v57
v_mfma_f32_32x32x16_bf16 v[120:135], v[96:99], v[112:115], v[120:135]
v_exp_f32 v90, v58
v_exp_f32 v91, v59
v_exp_f32 v92, v60
v_exp_f32 v93, v61
v_exp_f32_e64 v94, v62
v_exp_f32 v95, v63
buffer_load_dwordx4 v[248:251], v238, s[24:27], 0 offen
s_waitcnt lgkmcnt(0)
v_mfma_f32_32x32x16_bf16 v[80:95], v[8:11], v[8:11], v[80:95]
buffer_load_dword v32, v32, s[4:7], 0 offen sc1
buffer_load_dword v33, v33, s[4:7], 0 offen sc1
buffer_load_dword v34, v34, s[4:7], 0 offen sc1
buffer_load_dword v35, v35, s[4:7], 0 offen sc1
buffer_load_dword v36, v36, s[4:7], 0 offen sc1
buffer_load_dword v37, v37, s[4:7], 0 offen sc1
v_mfma_f32_32x32x16_bf16 v[120:135], v[100:103], v[116:119], v[120:135]
ds_write_b16 v239, v252
ds_write_b16 v239, v252 offset:64
s_nop 2
v_rcp_f32 v80, v80
v_rcp_f32_e64 v81, v81
v_mfma_f32_32x32x16_bf16 v[136:151], v[104:107], v[112:115], v[136:151]
v_rcp_f32 v82, v82
v_rcp_f32 v83, v83
v_rcp_f32 v84, v84
v_rcp_f32 v85, v85
v_rcp_f32_e64 v86, v86
v_mfma_f32_32x32x16_bf16 v[136:151], v[108:111], v[116:119], v[136:151]
v_rcp_f32 v87, v87
v_rcp_f32 v88, v88
v_rcp_f32 v89, v89
v_rcp_f32 v90, v90
v_rcp_f32 v91, v91
v_rcp_f32 v92, v92
v_rcp_f32 v93, v93
v_rcp_f32 v94, v94
v_rcp_f32_e64 v95, v95
v_pk_mul_f32 v[80:81], v[80:81], v[48:49]
v_pk_mul_f32 v[82:83], v[82:83], v[50:51]
v_pk_mul_f32 v[84:85], v[84:85], v[52:53]
v_pk_mul_f32 v[86:87], v[86:87], v[54:55]
v_pk_mul_f32 v[88:89], v[88:89], v[56:57]
v_pk_mul_f32 v[90:91], v[90:91], v[58:59]
v_pk_mul_f32 v[92:93], v[92:93], v[60:61]
v_pk_mul_f32 v[94:95], v[94:95], v[62:63]
v_bfi_b32 v199, s68, v234, v199
v_cvt_pk_bf16_f32 v96, v80, v81
v_cvt_pk_bf16_f32 v97, v82, v83
v_cvt_pk_bf16_f32 v98, v84, v85
v_cvt_pk_bf16_f32 v99, v86, v87
v_cvt_pk_bf16_f32 v100, v88, v89
v_cvt_pk_bf16_f32 v101, v90, v91
v_cvt_pk_bf16_f32 v102, v92, v93
v_cvt_pk_bf16_f32 v103, v94, v95
v_exp_f32 v80, v64
v_exp_f32 v81, v65
v_exp_f32 v82, v66
v_exp_f32 v83, v67
v_exp_f32 v84, v68
v_exp_f32 v85, v69
v_exp_f32 v86, v70
v_exp_f32 v87, v71
s_waitcnt vmcnt(17)
v_lshlrev_b32 v48, 16, v16
v_lshlrev_b32 v49, 16, v17
v_lshlrev_b32 v50, 16, v18
v_lshlrev_b32 v51, 16, v19
v_lshlrev_b32 v52, 16, v20
v_lshlrev_b32 v53, 16, v21
v_exp_f32 v88, v72
v_exp_f32 v89, v73
v_exp_f32 v90, v74
v_exp_f32 v91, v75
v_exp_f32 v92, v76
v_exp_f32 v93, v77
v_exp_f32 v94, v78
v_exp_f32 v95, v79
v_xor_b32 v239, v237, v240
v_cndmask_b32 v243, v236, 1.0, s[60:61]
v_mfma_f32_32x32x16_bf16 v[80:95], v[8:11], v[8:11], v[80:95]
ds_write_b16 v239, v236 offset:64
ds_write_b16_d16_hi v239, v243
ds_read_b128 v[112:115], v241
ds_read_b128 v[116:119], v242
buffer_load_dword v38, v38, s[4:7], 0 offen sc1
buffer_load_dword v39, v39, s[4:7], 0 offen sc1
buffer_load_dword v40, v40, s[4:7], 0 offen sc1
buffer_load_dword v41, v41, s[4:7], 0 offen sc1
buffer_load_dword v42, v42, s[4:7], 0 offen sc1
buffer_load_dword v43, v43, s[4:7], 0 offen sc1
buffer_load_dword v44, v44, s[4:7], 0 offen sc1
buffer_load_dword v45, v45, s[4:7], 0 offen sc1
buffer_load_dword v46, v46, s[4:7], 0 offen sc1
buffer_load_dword v47, v47, s[4:7], 0 offen sc1
v_add_u32 v232, 256, v232
v_add_u32 v233, 128, v233
s_sub_u32 s53, s53, 1
s_waitcnt vmcnt(17)
v_lshlrev_b32 v54, 16, v22
v_lshlrev_b32 v55, 16, v23
v_lshlrev_b32 v56, 16, v24
v_lshlrev_b32 v57, 16, v25
v_lshlrev_b32 v58, 16, v26
v_lshlrev_b32 v59, 16, v27
v_lshlrev_b32 v60, 16, v28
v_lshlrev_b32 v61, 16, v29
v_lshlrev_b32 v62, 16, v30
v_lshlrev_b32 v63, 16, v31
v_rcp_f32 v80, v80
v_rcp_f32 v81, v81
v_mfma_f32_32x32x16_bf16 v[48:63], v[196:199], v[160:163], v[48:63]
v_rcp_f32 v82, v82
v_rcp_f32 v83, v83
v_rcp_f32 v84, v84
v_rcp_f32 v85, v85
v_rcp_f32_e64 v86, v86
v_mfma_f32_32x32x16_bf16 v[48:63], v[192:195], v[152:155], v[48:63]
v_rcp_f32 v87, v87
v_rcp_f32 v88, v88
v_rcp_f32 v89, v89
v_rcp_f32 v90, v90
v_rcp_f32 v91, v91
v_rcp_f32 v92, v92
v_rcp_f32 v93, v93
v_rcp_f32 v94, v94
v_rcp_f32_e64 v95, v95
v_pk_mul_f32 v[80:81], v[80:81], v[64:65]
v_pk_mul_f32 v[82:83], v[82:83], v[66:67]
v_pk_mul_f32 v[84:85], v[84:85], v[68:69]
v_pk_mul_f32 v[86:87], v[86:87], v[70:71]
v_pk_mul_f32 v[88:89], v[88:89], v[72:73]
v_pk_mul_f32 v[90:91], v[90:91], v[74:75]
v_pk_mul_f32 v[92:93], v[92:93], v[76:77]
v_pk_mul_f32 v[94:95], v[94:95], v[78:79]
v_cvt_pk_bf16_f32 v104, v80, v81
v_cvt_pk_bf16_f32 v105, v82, v83
v_cvt_pk_bf16_f32 v106, v84, v85
v_cvt_pk_bf16_f32 v107, v86, v87
v_cvt_pk_bf16_f32 v108, v88, v89
v_cvt_pk_bf16_f32 v109, v90, v91
v_cvt_pk_bf16_f32 v110, v92, v93
v_cvt_pk_bf16_f32 v111, v94, v95
s_cbranch_scc0 L_l0
L_ev1:
s_cmp_eq_u32 s31, 1
s_cbranch_scc1 L_lt1
s_cmp_eq_u32 s54, -1
s_cbranch_scc1 L_tail
ds_read_b128 v[80:83], v247 offset:0
ds_read_b128 v[84:87], v247 offset:32
ds_read_b128 v[88:91], v247 offset:64
ds_read_b128 v[92:95], v247 offset:96
s_waitcnt lgkmcnt(4)
v_mfma_f32_32x32x16_bf16 v[120:135], v[96:99], v[112:115], v[120:135]
v_mfma_f32_32x32x16_bf16 v[136:151], v[104:107], v[112:115], v[136:151]
v_mfma_f32_32x32x16_bf16 v[120:135], v[100:103], v[116:119], v[120:135]
v_mfma_f32_32x32x16_bf16 v[136:151], v[108:111], v[116:119], v[136:151]
v_xor_b32 v241, 0x800, v241
v_xor_b32 v242, 0x800, v242
ds_read_b128 v[112:115], v241
ds_read_b128 v[116:119], v242
s_mov_b64 exec, s[58:59]
v_mov_b32 v160, v168
v_mov_b32 v161, v169
v_mov_b32 v162, v170
v_mov_b32 v163, v171
v_mov_b32 v164, v172
v_mov_b32 v165, v173
v_mov_b32 v166, v174
v_mov_b32 v167, v175
s_mov_b64 exec, -1
s_not_b64 s[58:59], s[58:59]
s_mov_b32 s53, s54
s_mov_b32 s54, s55
s_mov_b32 s55, s56
s_mov_b32 s56, -1
s_add_i32 s31, s31, 1
s_sub_u32 s93, s93, 1
s_cbranch_scc0 L_pr1916
s_setprio 0
L_pr1916:
v_xor_b32 v12, 32, v245
v_xor_b32_e64 v13, 64, v245
v_xor_b32 v14, 96, v245
v_cvt_pk_bf16_f32 v120, v120, v121
v_cvt_pk_bf16_f32 v121, v122, v123
v_cvt_pk_bf16_f32 v122, v124, v125
v_cvt_pk_bf16_f32 v123, v126, v127
v_cvt_pk_bf16_f32 v124, v128, v129
v_cvt_pk_bf16_f32 v125, v130, v131
v_cvt_pk_bf16_f32 v126, v132, v133
v_cvt_pk_bf16_f32 v127, v134, v135
v_cvt_pk_bf16_f32 v128, v136, v137
v_cvt_pk_bf16_f32 v129, v138, v139
v_cvt_pk_bf16_f32 v130, v140, v141
v_cvt_pk_bf16_f32 v131, v142, v143
v_cvt_pk_bf16_f32 v132, v144, v145
v_cvt_pk_bf16_f32 v133, v146, v147
v_cvt_pk_bf16_f32 v134, v148, v149
v_cvt_pk_bf16_f32 v135, v150, v151
s_mov_b64 exec, s[62:63]
ds_write_b128 v245, v[120:123]
ds_write_b128 v12, v[124:127]
ds_write_b128 v13, v[128:131]
ds_write_b128 v14, v[132:135]
s_mov_b64 exec, -1
s_waitcnt lgkmcnt(6)
v_mfma_f32_32x32x16_bf16 v[64:79], v[80:83], v[120:123], 0
v_mfma_f32_32x32x16_bf16 v[64:79], v[84:87], v[124:127], v[64:79]
v_mfma_f32_32x32x16_bf16 v[64:79], v[88:91], v[128:131], v[64:79]
v_mfma_f32_32x32x16_bf16 v[64:79], v[92:95], v[132:135], v[64:79]
v_mfma_f32_32x32x16_bf16 v[136:151], v[252:255], v[252:255], 0
v_mfma_f32_32x32x16_bf16 v[120:135], v[252:255], v[252:255], 0
v_add_u32 v245, 1792, v245
v_xor_b32_e64 v245, 64, v245
s_mov_b64 exec, s[60:61]
s_nop 6
ds_add_f32 v246, v64
s_mov_b64 exec, -1
v_add_u32 v246, 128, v246
s_branch L_l0
L_ev0:
s_cmp_eq_u32 s31, 1
s_cbranch_scc1 L_lt0
s_cmp_eq_u32 s54, -1
s_cbranch_scc1 L_tail
ds_read_b128 v[80:83], v247 offset:0
ds_read_b128 v[84:87], v247 offset:32
ds_read_b128 v[88:91], v247 offset:64
ds_read_b128 v[92:95], v247 offset:96
s_waitcnt lgkmcnt(4)
v_mfma_f32_32x32x16_bf16 v[120:135], v[96:99], v[112:115], v[120:135]
v_mfma_f32_32x32x16_bf16 v[136:151], v[104:107], v[112:115], v[136:151]
v_mfma_f32_32x32x16_bf16 v[120:135], v[100:103], v[116:119], v[120:135]
v_mfma_f32_32x32x16_bf16 v[136:151], v[108:111], v[116:119], v[136:151]
v_xor_b32 v241, 0x800, v241
v_xor_b32 v242, 0x800, v242
ds_read_b128 v[112:115], v241
ds_read_b128 v[116:119], v242
s_mov_b64 exec, s[58:59]
v_mov_b32 v160, v168
v_mov_b32 v161, v169
v_mov_b32 v162, v170
v_mov_b32 v163, v171
v_mov_b32 v164, v172
v_mov_b32 v165, v173
v_mov_b32 v166, v174
v_mov_b32 v167, v175
s_mov_b64 exec, -1
s_not_b64 s[58:59], s[58:59]
s_mov_b32 s53, s54
s_mov_b32 s54, s55
s_mov_b32 s55, s56
s_mov_b32 s56, -1
s_add_i32 s31, s31, 1
s_sub_u32 s93, s93, 1
s_cbranch_scc0 L_pr1993
s_setprio 0
L_pr1993:
v_xor_b32 v12, 32, v245
v_xor_b32_e64 v13, 64, v245
v_xor_b32 v14, 96, v245
v_cvt_pk_bf16_f32 v120, v120, v121
v_cvt_pk_bf16_f32 v121, v122, v123
v_cvt_pk_bf16_f32 v122, v124, v125
v_cvt_pk_bf16_f32 v123, v126, v127
v_cvt_pk_bf16_f32 v124, v128, v129
v_cvt_pk_bf16_f32 v125, v130, v131
v_cvt_pk_bf16_f32 v126, v132, v133
v_cvt_pk_bf16_f32 v127, v134, v135
v_cvt_pk_bf16_f32 v128, v136, v137
v_cvt_pk_bf16_f32 v129, v138, v139
v_cvt_pk_bf16_f32 v130, v140, v141
v_cvt_pk_bf16_f32 v131, v142, v143
v_cvt_pk_bf16_f32 v132, v144, v145
v_cvt_pk_bf16_f32 v133, v146, v147
v_cvt_pk_bf16_f32 v134, v148, v149
v_cvt_pk_bf16_f32 v135, v150, v151
s_mov_b64 exec, s[62:63]
ds_write_b128 v245, v[120:123]
ds_write_b128 v12, v[124:127]
ds_write_b128 v13, v[128:131]
ds_write_b128 v14, v[132:135]
s_mov_b64 exec, -1
s_waitcnt lgkmcnt(6)
v_mfma_f32_32x32x16_bf16 v[64:79], v[80:83], v[120:123], 0
v_mfma_f32_32x32x16_bf16 v[64:79], v[84:87], v[124:127], v[64:79]
v_mfma_f32_32x32x16_bf16 v[64:79], v[88:91], v[128:131], v[64:79]
v_mfma_f32_32x32x16_bf16 v[64:79], v[92:95], v[132:135], v[64:79]
v_mfma_f32_32x32x16_bf16 v[136:151], v[252:255], v[252:255], 0
v_mfma_f32_32x32x16_bf16 v[120:135], v[252:255], v[252:255], 0
v_add_u32 v245, 1792, v245
v_xor_b32 v245, 64, v245
s_mov_b64 exec, s[60:61]
s_nop 6
ds_add_f32 v246, v64
s_mov_b64 exec, -1
v_add_u32 v246, 128, v246
s_branch L_l1
L_wfp:
s_add_u32 s30, s30, 1
s_cmp_gt_u32 s30, 2000000
s_cbranch_scc1 L_end
buffer_load_dwordx2 v[118:119], v29, s[16:19], 0 offen sc1
s_waitcnt vmcnt(0)
v_cmp_ne_u64 vcc, s[66:67], v[118:119]
s_cbranch_vccnz L_wfp
s_branch L_wfd
L_poll:
s_and_b32 s88, s2, 7
s_lshl_b32 s88, s88, 3
s_add_u32 s88, s88, s3
s_lshl_b32 s88, s88, 10
v_and_b32_e64 v77, 31, v2
s_add_u32 s88, s88, 27918336
v_lshl_add_u32 v77, v77, 5, s88
L_poll2:
s_add_u32 s30, s30, 1
s_cmp_gt_u32 s30, 2000000
s_cbranch_scc1 L_end
buffer_load_dwordx2 v[78:79], v77, s[16:19], 0 offen sc1
s_waitcnt vmcnt(0)
v_cmp_ne_u64 vcc, s[66:67], v[78:79]
s_cbranch_vccnz L_poll2
s_branch L_polld
L_lt1:
s_setprio 0
s_mov_b32 s53, s29
s_mov_b32 s31, 2
s_branch L_l0
L_lt0:
s_setprio 0
s_mov_b32 s53, s29
s_mov_b32 s31, 2
s_branch L_l1
.p2align 12
L_t4:
s_branch L_tb4
s_nop 0
L_sg4:
L_tail:
ds_read_b128 v[80:83], v247 offset:0
ds_read_b128 v[84:87], v247 offset:32
ds_read_b128 v[88:91], v247 offset:64
ds_read_b128 v[92:95], v247 offset:96
v_lshlrev_b32 v15, 4, v2
s_add_u32 s83, s71, 4096
s_waitcnt lgkmcnt(4)
v_mfma_f32_32x32x16_bf16 v[120:135], v[96:99], v[112:115], v[120:135]
v_mfma_f32_32x32x16_bf16 v[136:151], v[104:107], v[112:115], v[136:151]
v_mfma_f32_32x32x16_bf16 v[120:135], v[100:103], v[116:119], v[120:135]
v_mfma_f32_32x32x16_bf16 v[136:151], v[108:111], v[116:119], v[136:151]
buffer_load_dwordx4 v[160:163], v15, s[16:19], s71 offen offset:0 sc1
buffer_load_dwordx4 v[164:167], v15, s[16:19], s71 offen offset:1024 sc1
buffer_load_dwordx4 v[168:171], v15, s[16:19], s71 offen offset:2048 sc1
buffer_load_dwordx4 v[172:175], v15, s[16:19], s71 offen offset:3072 sc1
buffer_load_dwordx4 v[48:51], v15, s[16:19], s83 offen offset:0 sc1
buffer_load_dwordx4 v[52:55], v15, s[16:19], s83 offen offset:1024 sc1
buffer_load_dwordx4 v[56:59], v15, s[16:19], s83 offen offset:2048 sc1
buffer_load_dwordx4 v[60:63], v15, s[16:19], s83 offen offset:3072 sc1
v_xor_b32 v12, 32, v245
v_xor_b32 v13, 64, v245
v_xor_b32 v14, 96, v245
s_lshl_b32 s82, s46, 3
v_mov_b32 v240, s82
v_mov_b32 v239, 1
s_lshl_b32 s82, s45, 7
v_xor_b32 v232, s82, v3
v_xor_b32 v233, 32, v232
v_xor_b32 v234, 64, v232
v_xor_b32 v235, 96, v232
v_xor_b32 v236, 128, v232
v_xor_b32 v237, 160, v232
v_xor_b32 v238, 192, v232
v_xor_b32 v7, 224, v232
v_cvt_pk_bf16_f32 v120, v120, v121
v_cvt_pk_bf16_f32 v121, v122, v123
v_cvt_pk_bf16_f32 v122, v124, v125
v_cvt_pk_bf16_f32 v123, v126, v127
v_cvt_pk_bf16_f32 v124, v128, v129
v_cvt_pk_bf16_f32 v125, v130, v131
v_cvt_pk_bf16_f32 v126, v132, v133
v_cvt_pk_bf16_f32 v127, v134, v135
v_cvt_pk_bf16_f32 v128, v136, v137
v_cvt_pk_bf16_f32 v129, v138, v139
v_cvt_pk_bf16_f32 v130, v140, v141
v_cvt_pk_bf16_f32 v131, v142, v143
v_cvt_pk_bf16_f32 v132, v144, v145
v_cvt_pk_bf16_f32 v133, v146, v147
v_cvt_pk_bf16_f32 v134, v148, v149
v_cvt_pk_bf16_f32 v135, v150, v151
s_mov_b64 exec, s[62:63]
s_waitcnt lgkmcnt(0)
ds_write_b128 v245, v[120:123]
ds_write_b128 v12, v[124:127]
ds_write_b128 v13, v[128:131]
ds_write_b128 v14, v[132:135]
s_mov_b64 exec, 1
ds_add_u32 v240, v239 offset:41152
s_mov_b64 exec, -1
ds_read_b128 v[96:99], v232
ds_read_b128 v[100:103], v233
ds_read_b128 v[104:107], v234
ds_read_b128 v[108:111], v235
v_mfma_f32_32x32x16_bf16 v[64:79], v[80:83], v[120:123], 0
v_mfma_f32_32x32x16_bf16 v[64:79], v[84:87], v[124:127], v[64:79]
v_mfma_f32_32x32x16_bf16 v[64:79], v[88:91], v[128:131], v[64:79]
v_mfma_f32_32x32x16_bf16 v[64:79], v[92:95], v[132:135], v[64:79]
ds_read_b32 v6, v240 offset:41152
ds_read_b128 v[112:115], v236
ds_read_b128 v[116:119], v237
ds_read_b128 v[152:155], v238
ds_read_b128 v[156:159], v7
s_waitcnt vmcnt(8)
s_waitcnt lgkmcnt(8)
v_mfma_f32_32x32x16_bf16 v[200:215], v[96:99], v[16:19], v[200:215]
s_mul_i32 s82, s45, 42
v_add_u32 v15, s82, v2
s_movk_i32 s83, 0x5556
v_mul_u32_u24 v8, s83, v15
v_lshrrev_b32 v8, 16, v8
v_mul_u32_u24 v9, 3, v8
v_sub_u32 v9, v15, v9
v_mul_u32_u24 v10, 147, v8
s_waitcnt lgkmcnt(7)
v_mfma_f32_32x32x16_bf16 v[200:215], v[100:103], v[24:27], v[200:215]
v_lshrrev_b32 v10, 10, v10
v_add_u32 v8, v8, v10
v_lshl_add_u32 v8, v8, 2, v9
s_lshl_b32 s83, s46, 9
v_lshl_add_u32 v241, v8, 2, s83
s_mul_i32 s83, s44, 588
s_mul_i32 s84, s47, 6
s_waitcnt lgkmcnt(6)
v_mfma_f32_32x32x16_bf16 v[200:215], v[104:107], v[32:35], v[200:215]
s_add_u32 s83, s83, s84
v_lshl_add_u32 v242, v15, 1, s83
s_cmp_ge_u32 s46, 2
s_cselect_b32 s83, 63, 84
s_add_u32 s84, s82, 42
s_min_u32 s83, s83, s84
v_cmp_gt_u32 s[86:87], s83, v15
s_mov_b64 exec, s[60:61]
ds_add_f32 v246, v64
s_mov_b64 exec, 1
ds_add_u32 v240, v239 offset:41156
s_mov_b64 exec, -1
s_waitcnt lgkmcnt(7)
v_mfma_f32_32x32x16_bf16 v[200:215], v[108:111], v[40:43], v[200:215]
s_waitcnt lgkmcnt(6)
v_cmp_gt_u32 vcc, 2, v6
s_cbranch_vccnz L_sy1
L_sy1d:
s_waitcnt vmcnt(7) lgkmcnt(5)
v_mfma_f32_32x32x16_bf16 v[200:215], v[112:115], v[160:163], v[200:215]
s_waitcnt vmcnt(5) lgkmcnt(4)
v_mfma_f32_32x32x16_bf16 v[200:215], v[116:119], v[168:171], v[200:215]
s_cmp_lg_u32 s35, 0
v_and_b32 v80, s68, v176
v_and_b32 v81, s68, v177
v_and_b32 v82, s68, v178
v_and_b32 v83, s68, v179
v_and_b32 v84, s68, v180
v_and_b32 v85, s68, v181
s_waitcnt vmcnt(3) lgkmcnt(3)
v_mfma_f32_32x32x16_bf16 v[200:215], v[152:155], v[48:51], v[200:215]
v_and_b32 v86, s68, v182
v_and_b32 v88, s68, v183
v_and_b32 v89, s68, v184
v_and_b32 v90, s68, v185
v_and_b32 v91, s68, v186
v_and_b32 v92, s68, v187
s_waitcnt vmcnt(0) lgkmcnt(2)
v_mfma_f32_32x32x16_bf16 v[200:215], v[156:159], v[56:59], v[200:215]
v_and_b32 v93, s68, v188
v_and_b32 v94, s68, v189
v_lshlrev_b32 v64, 16, v176
v_lshlrev_b32 v65, 16, v177
v_lshlrev_b32 v66, 16, v178
v_lshlrev_b32 v67, 16, v179
s_cbranch_scc1 L_mo
v_mfma_f32_32x32x16_bf16 v[216:231], v[96:99], v[20:23], v[216:231]
s_add_u32 s40, s36, 6400000
s_addc_u32 s41, s37, 0
s_mov_b32 s42, 150000
s_mov_b32 s43, 0x20000
v_lshlrev_b32 v68, 16, v180
v_lshlrev_b32 v69, 16, v181
v_lshlrev_b32 v70, 16, v182
v_lshlrev_b32 v72, 16, v183
v_lshlrev_b32 v73, 16, v184
v_lshlrev_b32 v74, 16, v185
v_lshlrev_b32 v75, 16, v186
v_lshlrev_b32 v76, 16, v187
v_lshlrev_b32 v77, 16, v188
v_lshlrev_b32 v78, 16, v189
v_mfma_f32_32x32x16_bf16 v[216:231], v[100:103], v[28:31], v[216:231]
v_exp_f32 v120, v200
v_exp_f32 v121, v201
v_exp_f32 v122, v202
v_mfma_f32_32x32x16_bf16 v[216:231], v[104:107], v[36:39], v[216:231]
v_exp_f32 v123, v203
v_exp_f32 v124, v204
v_exp_f32 v125, v205
v_exp_f32 v126, v206
v_mfma_f32_32x32x16_bf16 v[216:231], v[108:111], v[44:47], v[216:231]
v_exp_f32 v128, v208
v_exp_f32 v129, v209
v_exp_f32 v130, v210
v_exp_f32 v131, v211
v_mfma_f32_32x32x16_bf16 v[216:231], v[112:115], v[164:167], v[216:231]
v_exp_f32 v132, v212
v_exp_f32 v133, v213
v_exp_f32 v134, v214
v_pk_fma_f32 v[120:121], v[120:121], s[64:65], s[64:65]
v_pk_fma_f32 v[122:123], v[122:123], s[64:65], s[64:65]
v_mfma_f32_32x32x16_bf16 v[216:231], v[116:119], v[172:175], v[216:231]
ds_read_b32 v6, v240 offset:41156
ds_read_b32 v243, v241 offset:38916
ds_read_b32 v238, v241 offset:36864
v_pk_fma_f32 v[124:125], v[124:125], s[64:65], s[64:65]
v_pk_fma_f32 v[126:127], v[126:127], s[64:65], s[64:65]
v_pk_fma_f32 v[128:129], v[128:129], s[64:65], s[64:65]
v_pk_fma_f32 v[130:131], v[130:131], s[64:65], s[64:65]
v_pk_fma_f32 v[132:133], v[132:133], s[64:65], s[64:65]
v_pk_fma_f32 v[134:135], v[134:135], s[64:65], s[64:65]
v_mfma_f32_32x32x16_bf16 v[216:231], v[152:155], v[52:55], v[216:231]
v_rcp_f32 v120, v120
v_rcp_f32 v121, v121
v_rcp_f32 v122, v122
v_rcp_f32 v123, v123
v_mfma_f32_32x32x16_bf16 v[216:231], v[156:159], v[60:63], v[216:231]
v_rcp_f32 v124, v124
v_rcp_f32 v125, v125
v_rcp_f32 v126, v126
v_rcp_f32 v128, v128
v_rcp_f32 v129, v129
v_rcp_f32 v130, v130
v_rcp_f32 v131, v131
v_rcp_f32 v132, v132
v_rcp_f32 v133, v133
v_rcp_f32 v134, v134
v_pk_fma_f32 v[120:121], v[120:121], v[200:201], v[64:65]
v_pk_fma_f32 v[122:123], v[122:123], v[202:203], v[66:67]
v_pk_fma_f32 v[124:125], v[124:125], v[204:205], v[68:69]
v_pk_fma_f32 v[126:127], v[126:127], v[206:207], v[70:71]
v_pk_fma_f32 v[128:129], v[128:129], v[208:209], v[72:73]
v_pk_fma_f32 v[130:131], v[130:131], v[210:211], v[74:75]
v_pk_fma_f32 v[132:133], v[132:133], v[212:213], v[76:77]
v_pk_fma_f32 v[134:135], v[134:135], v[214:215], v[78:79]
s_mov_b32 s82, 0xbf317218
s_waitcnt lgkmcnt(0)
v_cmp_gt_u32 vcc, 2, v6
s_cbranch_vccnz L_sy2
L_sy2d:
v_fma_f32 v243, v243, s82, v238
v_cvt_pk_bf16_f32 v243, v243, v243
s_mov_b64 exec, s[86:87]
buffer_store_short v243, v242, s[40:43], 0 offen
s_mov_b64 exec, -1
v_exp_f32 v136, v216
v_exp_f32 v137, v217
v_exp_f32 v138, v218
v_exp_f32 v139, v219
v_exp_f32 v140, v220
v_exp_f32 v141, v221
v_exp_f32 v142, v222
v_exp_f32 v144, v224
v_exp_f32 v145, v225
v_exp_f32 v146, v226
v_exp_f32 v147, v227
v_exp_f32 v148, v228
v_exp_f32 v149, v229
v_exp_f32 v150, v230
v_pk_fma_f32 v[136:137], v[136:137], s[64:65], s[64:65]
v_pk_fma_f32 v[138:139], v[138:139], s[64:65], s[64:65]
v_pk_fma_f32 v[140:141], v[140:141], s[64:65], s[64:65]
v_pk_fma_f32 v[142:143], v[142:143], s[64:65], s[64:65]
v_pk_fma_f32 v[144:145], v[144:145], s[64:65], s[64:65]
v_pk_fma_f32 v[146:147], v[146:147], s[64:65], s[64:65]
v_pk_fma_f32 v[148:149], v[148:149], s[64:65], s[64:65]
v_pk_fma_f32 v[150:151], v[150:151], s[64:65], s[64:65]
v_rcp_f32 v136, v136
v_rcp_f32 v137, v137
v_rcp_f32 v138, v138
v_rcp_f32 v139, v139
v_rcp_f32 v140, v140
v_rcp_f32 v141, v141
v_rcp_f32 v142, v142
v_rcp_f32 v144, v144
v_rcp_f32 v145, v145
v_rcp_f32 v146, v146
v_rcp_f32 v147, v147
v_rcp_f32 v148, v148
v_rcp_f32 v149, v149
v_rcp_f32 v150, v150
v_pk_fma_f32 v[136:137], v[136:137], v[216:217], v[80:81]
v_pk_fma_f32 v[138:139], v[138:139], v[218:219], v[82:83]
v_cvt_pk_bf16_f32 v120, v120, v136
buffer_store_dword v120, v4, s[36:39], 0 offen offset:0 sc0 sc1
v_cvt_pk_bf16_f32 v121, v121, v137
buffer_store_dword v121, v4, s[36:39], 0 offen offset:256 sc0 sc1
v_pk_fma_f32 v[140:141], v[140:141], v[220:221], v[84:85]
v_cvt_pk_bf16_f32 v122, v122, v138
buffer_store_dword v122, v4, s[36:39], 0 offen offset:512 sc0 sc1
v_cvt_pk_bf16_f32 v123, v123, v139
buffer_store_dword v123, v4, s[36:39], 0 offen offset:768 sc0 sc1
v_pk_fma_f32 v[142:143], v[142:143], v[222:223], v[86:87]
v_cvt_pk_bf16_f32 v124, v124, v140
buffer_store_dword v124, v4, s[36:39], 0 offen offset:1024 sc0 sc1
v_cvt_pk_bf16_f32 v125, v125, v141
buffer_store_dword v125, v4, s[36:39], 0 offen offset:1280 sc0 sc1
v_pk_fma_f32 v[144:145], v[144:145], v[224:225], v[88:89]
v_cvt_pk_bf16_f32 v126, v126, v142
buffer_store_dword v126, v4, s[36:39], 0 offen offset:1536 sc0 sc1
v_pk_fma_f32 v[146:147], v[146:147], v[226:227], v[90:91]
v_cvt_pk_bf16_f32 v128, v128, v144
buffer_store_dword v128, v5, s[36:39], 0 offen offset:0 sc0 sc1
v_cvt_pk_bf16_f32 v129, v129, v145
buffer_store_dword v129, v5, s[36:39], 0 offen offset:256 sc0 sc1
v_pk_fma_f32 v[148:149], v[148:149], v[228:229], v[92:93]
v_cvt_pk_bf16_f32 v130, v130, v146
buffer_store_dword v130, v5, s[36:39], 0 offen offset:512 sc0 sc1
v_cvt_pk_bf16_f32 v131, v131, v147
buffer_store_dword v131, v5, s[36:39], 0 offen offset:768 sc0 sc1
v_pk_fma_f32 v[150:151], v[150:151], v[230:231], v[94:95]
v_cvt_pk_bf16_f32 v132, v132, v148
buffer_store_dword v132, v5, s[36:39], 0 offen offset:1024 sc0 sc1
v_cvt_pk_bf16_f32 v133, v133, v149
buffer_store_dword v133, v5, s[36:39], 0 offen offset:1280 sc0 sc1
v_cvt_pk_bf16_f32 v134, v134, v150
buffer_store_dword v134, v5, s[36:39], 0 offen offset:1536 sc0 sc1
s_endpgm
L_retry:
s_lshr_b32 s49, s49, 2
s_branch L_again
L_more:
s_mov_b32 s50, 0
s_add_u32 s48, s48, s51
L_again:
s_load_dwordx2 s[8:9], s[0:1], 40
s_mov_b32 s10, 65536
s_waitcnt vmcnt(0) lgkmcnt(0)
s_barrier
v_mov_b32 v15, 0x40000000
v_mov_b32 v40, 0
ds_write_b32 v1, v40 offset:40960
v_lshlrev_b32 v14, 4, v2
v_lshrrev_b32 v56, 4, v2
v_and_b32 v57, 15, v2
s_lshl_b32 s82, s45, 4
v_lshl_add_u32 v58, v56, 2, s82
v_lshlrev_b32 v59, 8, v56
s_mov_b32 s88, 0x4a983210
s_mov_b32 s89, 0xc7654a98
s_mov_b32 s90, 0x10edc765
s_cmp_eq_u32 s46, 1
s_cselect_b32 s88, 0x10edc765, s88
s_cselect_b32 s89, 0x983210ed, s89
s_cselect_b32 s90, 0x210a9832, s90
s_cmp_eq_u32 s46, 2
s_cselect_b32 s88, 0x654a9832, s88
s_cselect_b32 s89, 0xedc7654a, s89
s_cselect_b32 s90, 0x7654a983, s90
s_cmp_eq_u32 s46, 3
s_cselect_b32 s88, 0x3210edc7, s88
s_cselect_b32 s89, 0x4a983210, s89
s_cselect_b32 s90, 0x83210edc, s90
s_mul_i32 s83, s44, 25088
s_lshl_b32 s57, s3, 10
s_add_u32 s84, s83, s57
v_bfe_u32 v60, s88, v58, 4
v_xor_b32 v60, v60, v57
v_lshl_add_u32 v60, v60, 4, v59
s_add_u32 m0, s57, 136960
s_add_u32 s82, s84, 0
buffer_load_dwordx4 v60, s[20:23], s82 offen lds
v_bfe_u32 v61, s89, v58, 4
v_xor_b32 v61, v61, v57
v_lshl_add_u32 v61, v61, 4, v59
s_add_u32 m0, s57, 145152
s_add_u32 s82, s84, 8192
buffer_load_dwordx4 v61, s[20:23], s82 offen lds
v_bfe_u32 v62, s90, v58, 4
v_xor_b32 v62, v62, v57
v_lshl_add_u32 v62, v62, 4, v59
s_add_u32 m0, s57, 153344
s_add_u32 s82, s84, 16384
buffer_load_dwordx4 v62, s[20:23], s82 offen lds
v_add_u32 v58, 9, v56
v_xor_b32 v58, v58, v57
v_lshl_add_u32 v63, v58, 4, v59
s_add_u32 s82, s83, 24576
s_mov_b32 m0, 161536
s_mov_b64 exec, s[60:61]
buffer_load_dwordx4 v63, s[20:23], s82 offen lds
s_mov_b64 exec, -1
v_lshlrev_b32 v99, 2, v56
v_xor_b32 v99, v99, v57
v_lshlrev_b32 v99, 4, v99
v_lshl_add_u32 v99, v56, 8, v99
s_add_u32 m0, s57, 51840
s_add_u32 s82, s57, 0
buffer_load_dwordx4 v99, s[8:11], s82 offen lds
s_add_u32 m0, s57, 60032
s_add_u32 s82, s57, 8192
buffer_load_dwordx4 v99, s[8:11], s82 offen lds
s_add_u32 m0, s57, 68224
s_add_u32 s82, s57, 16384
buffer_load_dwordx4 v99, s[8:11], s82 offen lds
s_add_u32 m0, s57, 76416
s_add_u32 s82, s57, 24576
buffer_load_dwordx4 v99, s[8:11], s82 offen lds
s_mov_b32 s8, s32
s_mov_b32 s9, s33
s_mov_b32 s10, 6400000
v_lshrrev_b32 v6, 1, v0
v_cmp_gt_u32 vcc, 250, v6
v_lshlrev_b32 v98, 6, v6
v_mul_u32_u24 v6, 1600, v6
s_mov_b64 s[78:79], vcc
v_cndmask_b32 v98, v15, v98, vcc
s_mov_b32 s10, 0
buffer_load_dwordx2 v[96:97], v98, s[16:19], s34 offen sc1
v_and_b32 v197, 31, v2
v_lshrrev_b32 v47, 5, v2
v_lshrrev_b32 v40, 4, v197
v_bfe_u32 v41, v197, 2, 1
v_lshl_add_u32 v40, v40, 1, v41
v_and_b32 v41, 3, v197
v_bfe_u32 v42, v197, 3, 1
v_lshl_add_u32 v41, v42, 2, v41
v_mul_u32_u24 v43, 7, v40
v_add3_u32 v43, v43, v41, s47
v_min_u32 v43, 97, v43
v_and_b32 v44, 15, v197
v_xor_b32 v44, v44, v47
v_lshlrev_b32 v44, 4, v44
v_lshl_add_u32 v43, v43, 8, v44
v_add_u32 v3, 136960, v43
s_lshl_b32 s88, s3, 12
v_lshlrev_b32 v40, 4, v40
v_lshl_add_u32 v40, v41, 1, v40
v_add_u32 v240, s88, v40
v_bfe_u32 v40, v197, 2, 2
v_xor_b32 v40, v40, v47
v_lshlrev_b32 v40, 4, v40
v_lshl_add_u32 v40, v197, 6, v40
v_add_u32 v241, s88, v40
v_xor_b32 v242, 32, v241
v_mov_b32 v239, v240
v_bfe_u32 v40, v2, 2, 2
v_lshl_add_u32 v41, v47, 3, v40
v_lshlrev_b32 v41, 8, v41
v_bfe_u32 v42, v2, 4, 1
v_lshlrev_b32 v42, 1, v42
v_bfe_u32 v43, v2, 1, 1
v_add_u32 v42, v42, v43
v_lshl_add_u32 v41, v42, 4, v41
v_and_b32 v43, 1, v2
v_lshl_add_u32 v41, v43, 3, v41
s_lshl_b32 s88, s45, 1
v_xor_b32 v42, s88, v40
v_xor_b32 v43, 1, v42
v_lshl_add_u32 v12, v42, 6, v41
v_lshl_add_u32 v13, v43, 6, v41
s_mul_i32 s88, s44, 98
s_add_u32 s88, s88, s47
s_lshl_b32 s88, s88, 8
s_lshl_b32 s89, s45, 7
s_add_u32 s88, s88, s89
v_mul_u32_u24 v40, 1792, v47
v_lshl_add_u32 v40, v197, 2, v40
v_add_u32 v4, s88, v40
s_cmp_ge_u32 s46, 2
s_cselect_b32 s89, 0x40000000, 0
v_mul_lo_u32 v40, v47, s89
v_add_u32 v5, 3584, v4
v_add_u32 v5, v5, v40
s_mov_b64 s[58:59], s[60:61]
s_waitcnt vmcnt(0) lgkmcnt(0)
s_barrier
ds_read_b128 v[120:123], v3
v_xor_b32 v57, 32, v3
ds_read_b128 v[124:127], v57
v_xor_b32 v56, 64, v3
ds_read_b128 v[128:131], v56
v_xor_b32 v57, 96, v3
ds_read_b128 v[132:135], v57
v_xor_b32 v56, 128, v3
ds_read_b128 v[136:139], v56
v_xor_b32 v57, 160, v3
ds_read_b128 v[140:143], v57
v_xor_b32 v56, 192, v3
ds_read_b128 v[144:147], v56
v_xor_b32 v57, 224, v3
ds_read_b128 v[148:151], v57
s_waitcnt lgkmcnt(0)
s_branch L_round
L_wff:
s_waitcnt vmcnt(6)
s_barrier
s_cmp_gt_u32 s72, 2
s_cbranch_scc1 L_wffd
s_mov_b64 exec, 1
buffer_store_dwordx2 v[172:173], off, s[16:19], s73 sc0 sc1
s_mov_b64 exec, -1
s_branch L_wffd
L_5a:
buffer_load_dwordx2 v[96:97], v96, s[16:19], s85 offen sc1
s_branch L_5ad
L_5c:
v_xor_b32 v96, s12, v96
v_xor_b32 v97, s13, v97
v_and_or_b32 v10, v96, s14, v97
v_cmp_gt_u32 vcc, s90, v10
s_cmp_lg_u64 vcc, s[80:81]
s_cbranch_scc1 L_rrt
s_branch L_5cd
L_rrt:
s_add_u32 s30, s30, 1
s_cmp_gt_u32 s30, 2000000
s_cbranch_scc1 L_end
s_mov_b32 s85, 8388608
v_subrev_u32 v80, s91, v24
v_lshrrev_b32 v80, 2, v80
v_cndmask_b32 v80, v15, v80, s[72:73]
buffer_load_dwordx2 v[80:81], v80, s[16:19], s85 offen sc1
v_subrev_u32 v84, s91, v25
v_lshrrev_b32 v84, 2, v84
v_cndmask_b32 v84, v15, v84, s[74:75]
buffer_load_dwordx2 v[84:85], v84, s[16:19], s85 offen sc1
v_subrev_u32 v88, s91, v26
v_lshrrev_b32 v88, 2, v88
v_cndmask_b32 v88, v15, v88, s[76:77]
buffer_load_dwordx2 v[88:89], v88, s[16:19], s85 offen sc1
v_subrev_u32 v92, s91, v27
v_lshrrev_b32 v92, 2, v92
v_cndmask_b32 v92, v15, v92, s[78:79]
buffer_load_dwordx2 v[92:93], v92, s[16:19], s85 offen sc1
v_subrev_u32 v96, s91, v28
v_lshrrev_b32 v96, 2, v96
v_cndmask_b32 v96, v15, v96, s[80:81]
buffer_load_dwordx2 v[96:97], v96, s[16:19], s85 offen sc1
s_waitcnt vmcnt(0)
s_branch L_rck
L_5b:
v_lshrrev_b32 v15, 25, v96
v_lshl_add_u32 v97, v97, 5, v28
v_and_b32 v15, 60, v15
s_mov_b64 exec, s[80:81]
ds_add_rtn_u32 v10, v15, v46 offset:40960
s_mov_b64 exec, -1
v_mad_u32_u16 v98, v96, 6, 0
v_and_b32 v98, -4, v98
buffer_load_dwordx2 v[98:99], v98, s[40:43], 0 offen
s_branch L_5bd
L_5p:
v_lshlrev_b32_sdwa v116, 4, v96 dst_sel:DWORD dst_unused:UNUSED_PAD src0_sel:DWORD src1_sel:BYTE_3
ds_read_b128 v[116:119], v116 offset:36864
v_bfe_u32 v20, v96, 16, 12
v_mad_u32_u16 v96, v96, 8, 0
v_xor_b32 v28, 128, v20
v_add_u32 v36, 16, v97
s_waitcnt vmcnt(0) lgkmcnt(0)
v_lshlrev_b32 v52, 1, v96
v_alignbit_b32 v98, v99, v98, v52
v_bfe_u32 v99, v99, v52, 16
v_dot2_f32_bf16 v116, v98, s69, v116
v_dot2_f32_bf16 v117, v98, s70, v117
v_dot2_f32_bf16 v118, v99, s69, v118
s_nop 2
v_cvt_pk_bf16_f32 v117, v118, v117
v_cvt_pk_bf16_f32 v118, v116, 0
v_dot2_f32_bf16 v119, v117, v117, 0
s_nop 2
v_dot2_f32_bf16 v119, v118, v118, v119
s_nop 2
v_cvt_pk_bf16_f32 v116, v116, v119
s_branch L_5pd
L_5d:
ds_read_b32 v44, v15 offset:41088
s_waitcnt lgkmcnt(0)
v_add_lshl_u32 v44, v44, v10, 2
s_mov_b64 exec, s[80:81]
ds_write_b32 v44, v96
ds_write2st64_b32 v44, v116, v117 offset0:35 offset1:70
ds_write2st64_b32 v44, v20, v28 offset0:105 offset1:140
ds_write2st64_b32 v44, v97, v36 offset0:175 offset1:210
s_mov_b64 exec, -1
s_branch L_5dd
L_padl:
v_subrev_u32 v46, 32, v46
v_add_u32 v45, 128, v45
v_cmpx_gt_i32 vcc, v46, v197
s_cbranch_execz L_padd
ds_write_b32 v45, v252
ds_write2st64_b32 v45, v252, v252 offset0:35 offset1:70
ds_write2st64_b32 v45, v198, v199 offset0:105 offset1:140
ds_write2st64_b32 v45, v249, v249 offset0:175 offset1:210
s_branch L_padl
L_sy1:
s_add_u32 s30, s30, 1
s_cmp_gt_u32 s30, 2000000
s_cbranch_scc1 L_end
ds_read_b32 v6, v240 offset:41152
s_waitcnt lgkmcnt(0)
v_cmp_gt_u32 vcc, 2, v6
s_cbranch_vccnz L_sy1
ds_read_b128 v[112:115], v236
ds_read_b128 v[116:119], v237
ds_read_b128 v[152:155], v238
ds_read_b128 v[156:159], v7
s_waitcnt lgkmcnt(0)
s_branch L_sy1d
L_mo:
v_mfma_f32_32x32x16_bf16 v[216:231], v[96:99], v[20:23], v[216:231]
v_mfma_f32_32x32x16_bf16 v[216:231], v[100:103], v[28:31], v[216:231]
v_mfma_f32_32x32x16_bf16 v[216:231], v[104:107], v[36:39], v[216:231]
v_mfma_f32_32x32x16_bf16 v[216:231], v[108:111], v[44:47], v[216:231]
v_mfma_f32_32x32x16_bf16 v[216:231], v[112:115], v[164:167], v[216:231]
v_mfma_f32_32x32x16_bf16 v[216:231], v[116:119], v[172:175], v[216:231]
v_mfma_f32_32x32x16_bf16 v[216:231], v[152:155], v[52:55], v[216:231]
v_mfma_f32_32x32x16_bf16 v[216:231], v[156:159], v[60:63], v[216:231]
s_branch L_more
L_sy2:
s_add_u32 s30, s30, 1
s_cmp_gt_u32 s30, 2000000
s_cbranch_scc1 L_end
ds_read_b32 v6, v240 offset:41156
s_waitcnt lgkmcnt(0)
v_cmp_gt_u32 vcc, 2, v6
s_cbranch_vccnz L_sy2
ds_read_b32 v243, v241 offset:38916
s_waitcnt lgkmcnt(0)
s_branch L_sy2d
.p2align 12
L_t5:
s_branch L_tb5
s_nop 0
L_sg5:
L_spec:
v_lshlrev_b32 v14, 4, v2
s_sub_u32 s88, s2, 251
s_cmp_gt_u32 s88, 2
s_cbranch_scc1 L_sp1
s_cmp_eq_u32 s2, 253
s_cbranch_scc1 L_small
s_mov_b32 s8, s86
s_mov_b32 s9, s87
s_mov_b32 s10, 65536
s_cmp_eq_u32 s2, 252
s_cselect_b32 s88, 32768, 0
s_lshl_b32 s89, s3, 12
s_add_u32 s88, s88, s89
s_add_u32 m0, s89, 104192
s_nop 0
buffer_load_dwordx4 v14, s[8:11], s88 offen offset:0 lds
buffer_load_dwordx4 v14, s[8:11], s88 offen offset:1024 lds
buffer_load_dwordx4 v14, s[8:11], s88 offen offset:2048 lds
buffer_load_dwordx4 v14, s[8:11], s88 offen offset:3072 lds
s_branch L_sp1
L_small:
s_add_u32 s8, s82, 65536
s_addc_u32 s9, s83, 0
s_movk_i32 s10, 4352
s_mov_b32 s12, s84
s_mov_b32 s13, s85
s_movk_i32 s14, 256
s_and_b32 s88, s3, 3
s_lshl_b32 s88, s88, 6
v_and_b32 v40, 31, v2
v_lshrrev_b32 v41, 5, v2
v_lshl_add_u32 v40, v40, 1, s88
v_lshl_add_u32 v41, v41, 11, v40
buffer_load_ushort v16, v41, s[8:11], 0 offen offset:256
buffer_load_ushort v17, v41, s[8:11], 0 offen offset:512
buffer_load_ushort v18, v41, s[8:11], 0 offen offset:768
buffer_load_ushort v19, v41, s[8:11], 0 offen offset:1024
buffer_load_ushort v20, v41, s[8:11], 0 offen offset:1280
buffer_load_ushort v21, v41, s[8:11], 0 offen offset:1536
buffer_load_ushort v22, v41, s[8:11], 0 offen offset:1792
buffer_load_ushort v23, v41, s[8:11], 0 offen offset:2048
v_and_b32 v42, 0x38, v2
v_lshlrev_b32 v42, 2, v42
v_bfe_u32 v43, v2, 1, 1
v_lshl_add_u32 v42, v43, 4, v42
v_bfe_u32 v43, v2, 2, 1
v_lshl_add_u32 v42, v43, 3, v42
v_and_b32 v43, 1, v2
v_lshl_add_u32 v42, v43, 2, v42
buffer_load_dword v24, v42, s[12:15], 0 offen
buffer_load_ushort v25, v40, s[8:11], 0 offen
L_sp1:
s_mov_b32 s8, s82
s_mov_b32 s9, s83
s_mov_b32 s10, 65536
s_and_b32 s44, s2, 7
s_lshl_b32 s44, s44, 5
s_lshr_b32 s82, s2, 3
s_add_u32 s44, s44, s82
s_and_b32 s45, s3, 1
s_lshr_b32 s46, s3, 1
s_mov_b32 s60, -1
s_mov_b32 s61, 0
s_mov_b32 s20, s72
s_mov_b32 s21, s73
s_mov_b32 s22, 6400000
s_mov_b32 s23, 0x20000
v_lshlrev_b32 v14, 4, v2
v_lshrrev_b32 v56, 4, v2
v_and_b32 v57, 15, v2
s_lshl_b32 s82, s45, 4
v_lshl_add_u32 v58, v56, 2, s82
v_lshlrev_b32 v59, 8, v56
s_mov_b32 s88, 0x4a983210
s_mov_b32 s89, 0xc7654a98
s_mov_b32 s90, 0x10edc765
s_cmp_eq_u32 s46, 1
s_cselect_b32 s88, 0x10edc765, s88
s_cselect_b32 s89, 0x983210ed, s89
s_cselect_b32 s90, 0x210a9832, s90
s_cmp_eq_u32 s46, 2
s_cselect_b32 s88, 0x654a9832, s88
s_cselect_b32 s89, 0xedc7654a, s89
s_cselect_b32 s90, 0x7654a983, s90
s_cmp_eq_u32 s46, 3
s_cselect_b32 s88, 0x3210edc7, s88
s_cselect_b32 s89, 0x4a983210, s89
s_cselect_b32 s90, 0x83210edc, s90
s_mul_i32 s83, s44, 25088
s_lshl_b32 s57, s3, 10
s_add_u32 s84, s83, s57
v_bfe_u32 v60, s88, v58, 4
v_xor_b32 v60, v60, v57
v_lshl_add_u32 v60, v60, 4, v59
s_add_u32 m0, s57, 136960
s_add_u32 s82, s84, 0
buffer_load_dwordx4 v60, s[20:23], s82 offen lds
v_bfe_u32 v61, s89, v58, 4
v_xor_b32 v61, v61, v57
v_lshl_add_u32 v61, v61, 4, v59
s_add_u32 m0, s57, 145152
s_add_u32 s82, s84, 8192
buffer_load_dwordx4 v61, s[20:23], s82 offen lds
v_bfe_u32 v62, s90, v58, 4
v_xor_b32 v62, v62, v57
v_lshl_add_u32 v62, v62, 4, v59
s_add_u32 m0, s57, 153344
s_add_u32 s82, s84, 16384
buffer_load_dwordx4 v62, s[20:23], s82 offen lds
v_add_u32 v58, 9, v56
v_xor_b32 v58, v58, v57
v_lshl_add_u32 v63, v58, 4, v59
s_add_u32 s82, s83, 24576
s_mov_b32 m0, 161536
s_mov_b64 exec, s[60:61]
buffer_load_dwordx4 v63, s[20:23], s82 offen lds
s_mov_b64 exec, -1
s_mov_b32 s40, s74
s_mov_b32 s41, s75
s_mov_b32 s42, 150000
s_mov_b32 s43, 0x20000
s_mov_b32 s16, s32
s_mov_b32 s17, s33
s_mov_b32 s18, 28311552
s_mov_b32 s19, 0x20000
s_mov_b32 s24, s76
s_mov_b32 s25, s77
s_mov_b32 s26, 12800000
s_mov_b32 s27, 0x20000
s_mov_b32 s36, s28
s_mov_b32 s37, s29
s_mov_b32 s38, 6400000
s_mov_b32 s39, 0x20000
s_mov_b32 s12, s30
s_mov_b32 s13, s31
s_movk_i32 s14, 256
s_mov_b32 s30, 0
s_mul_i32 s47, s46, 28
s_min_u32 s47, s47, 77
v_lshlrev_b32 v1, 2, v2
v_lshlrev_b32 v99, 2, v56
v_xor_b32 v99, v99, v57
v_lshlrev_b32 v99, 4, v99
v_lshl_add_u32 v99, v56, 8, v99
s_add_u32 m0, s57, 0
s_add_u32 s82, s57, 32768
buffer_load_dwordx4 v99, s[8:11], s82 offen lds
s_add_u32 m0, s57, 8192
s_add_u32 s82, s57, 40960
buffer_load_dwordx4 v99, s[8:11], s82 offen lds
s_add_u32 m0, s57, 16384
s_add_u32 s82, s57, 49152
buffer_load_dwordx4 v99, s[8:11], s82 offen lds
s_add_u32 m0, s57, 24576
s_add_u32 s82, s57, 57344
buffer_load_dwordx4 v99, s[8:11], s82 offen lds
buffer_load_dwordx2 v[172:173], off, s[12:15], 0 sc1
v_and_b32 v197, 31, v2
v_lshrrev_b32 v47, 5, v2
v_lshrrev_b32 v40, 4, v197
v_bfe_u32 v41, v197, 2, 1
v_lshl_add_u32 v40, v40, 1, v41
v_and_b32 v41, 3, v197
v_bfe_u32 v42, v197, 3, 1
v_lshl_add_u32 v41, v42, 2, v41
v_mul_u32_u24 v43, 7, v40
v_add3_u32 v43, v43, v41, s47
v_min_u32 v43, 97, v43
v_and_b32 v44, 15, v197
v_xor_b32 v44, v44, v47
v_lshlrev_b32 v44, 4, v44
v_lshl_add_u32 v43, v43, 8, v44
v_add_u32 v3, 136960, v43
s_lshl_b32 s88, s3, 12
v_lshlrev_b32 v40, 4, v40
v_lshl_add_u32 v40, v41, 1, v40
v_add_u32 v240, s88, v40
v_bfe_u32 v40, v197, 2, 2
v_xor_b32 v40, v40, v47
v_lshlrev_b32 v40, 4, v40
v_lshl_add_u32 v40, v197, 6, v40
v_add_u32 v241, s88, v40
v_xor_b32 v242, 32, v241
v_mov_b32 v239, v240
v_bfe_u32 v40, v2, 2, 2
v_lshl_add_u32 v41, v47, 3, v40
v_lshlrev_b32 v41, 8, v41
v_bfe_u32 v42, v2, 4, 1
v_lshlrev_b32 v42, 1, v42
v_bfe_u32 v43, v2, 1, 1
v_add_u32 v42, v42, v43
v_lshl_add_u32 v41, v42, 4, v41
v_and_b32 v43, 1, v2
v_lshl_add_u32 v41, v43, 3, v41
s_lshl_b32 s88, s45, 1
v_xor_b32 v42, s88, v40
v_xor_b32 v43, 1, v42
v_lshl_add_u32 v12, v42, 6, v41
v_lshl_add_u32 v13, v43, 6, v41
s_cmp_lg_u32 s3, 6
s_cbranch_scc1 L_pad1
v_mov_b32 v46, 0x3f80
v_bfe_u32 v40, v2, 4, 1
v_bfe_u32 v41, v2, 1, 3
v_and_b32 v42, 1, v2
v_lshlrev_b32 v43, 11, v40
v_lshl_add_u32 v43, v41, 8, v43
v_lshl_add_u32 v43, v42, 7, v43
v_and_b32 v44, 3, v41
v_lshl_add_u32 v43, v44, 4, v43
v_xor_b32 v40, v40, v42
v_lshl_add_u32 v40, v40, 4, v41
v_cmp_eq_u32 vcc, 0, v40
s_nop 1
v_cndmask_b32 v36, 0, v46, vcc
v_cmp_eq_u32 vcc, 1, v40
s_nop 1
v_cndmask_b32 v36, v36, 1.0, vcc
v_cmp_eq_u32 vcc, 2, v40
s_nop 1
v_cndmask_b32 v37, 0, v46, vcc
v_cmp_eq_u32 vcc, 3, v40
s_nop 1
v_cndmask_b32 v37, v37, 1.0, vcc
v_cmp_eq_u32 vcc, 4, v40
s_nop 1
v_cndmask_b32 v38, 0, v46, vcc
v_cmp_eq_u32 vcc, 5, v40
s_nop 1
v_cndmask_b32 v38, v38, 1.0, vcc
v_cmp_eq_u32 vcc, 6, v40
s_nop 1
v_cndmask_b32 v39, 0, v46, vcc
ds_write_b128 v43, v[36:39] offset:32768
L_pad1:
s_mov_b32 s68, 0xffff0000
s_mov_b32 s64, 0xbfb8aa3b
s_mov_b32 s65, 0xbfb8aa3b
s_lshr_b32 s88, s44, 3
s_mul_i32 s88, s88, 16000
s_and_b32 s89, s44, 7
s_lshl_b32 s89, s89, 3
s_add_u32 s88, s88, s89
s_add_u32 s34, s88, 27262976
s_mov_b32 s54, 0x7fff0000
v_lshrrev_b32 v40, 3, v0
s_mul_i32 s88, s44, 98
v_sub_u32 v40, v0, v40
v_cmp_lt_u32 vcc, 95, v0
v_add_u32 v40, s88, v40
v_subrev_u32 v41, 7, v40
v_cndmask_b32 v40, v40, v41, vcc
v_cmp_gt_u32 vcc, 120, v0
v_and_b32 v102, 1, v40
v_mul_u32_u24 v40, 6, v40
v_lshlrev_b32 v102, 4, v102
v_and_b32 v40, -4, v40
v_cndmask_b32 v40, v15, v40, vcc
buffer_load_dwordx2 v[100:101], v40, s[40:43], 0 offen
v_lshrrev_b32 v6, 1, v0
v_cmp_gt_u32 vcc, 250, v6
v_lshlrev_b32 v98, 6, v6
v_mul_u32_u24 v6, 1600, v6
s_mov_b64 s[78:79], vcc
v_cndmask_b32 v98, v15, v98, vcc
v_lshlrev_b32 v9, 4, v0
v_mov_b32 v61, 0
s_mul_i32 s56, s2, 12800
v_cmp_gt_u32 vcc, 0x120, v0
s_add_u32 s56, s56, 8388608
v_add_u32 v10, 8192, v9
v_add_u32 v103, 84608, v9
v_cndmask_b32 v10, v15, v10, vcc
s_and_b32 s72, s3, 3
s_lshl_b32 s72, s72, 13
s_lshr_b32 s73, s3, 2
s_lshl_b32 s73, s73, 7
s_add_u32 s72, s72, s73
s_add_u32 s72, s72, 104192
s_cmp_eq_u32 s2, 252
s_cselect_b32 s76, 10, 11
v_lshlrev_b32 v50, 2, v197
v_lshlrev_b32 v51, s76, v47
v_add3_u32 v50, v50, v51, s72
v_add_u32 v51, 2, v50
s_sub_u32 s74, s2, 250
s_lshl_b32 s74, s74, 15
s_lshl_b32 s75, s3, 12
s_add_u32 s74, s74, s75
s_add_u32 s74, s74, 27787264
s_mov_b32 s77, 0x05040100
s_mov_b32 s64, 0xbfb8aa3b
s_sub_u32 s72, s2, 251
s_cmp_gt_u32 s72, 2
s_waitcnt vmcnt(10) lgkmcnt(0)
s_barrier
s_cbranch_scc1 L_sp0
s_cmp_eq_u32 s2, 253
s_cbranch_scc1 L_sm2
s_cmp_eq_u32 s2, 252
s_cbranch_scc1 L_w2
ds_read_u16 v64, v50 offset:0
ds_read_u16 v65, v50 offset:256
ds_read_u16 v66, v50 offset:512
ds_read_u16 v67, v50 offset:768
ds_read_u16 v68, v50 offset:1024
ds_read_u16 v69, v50 offset:1280
ds_read_u16 v70, v50 offset:1536
ds_read_u16 v71, v50 offset:1792
s_waitcnt lgkmcnt(0)
v_perm_b32 v64, v65, v64, s77
v_perm_b32 v65, v67, v66, s77
v_perm_b32 v66, v69, v68, s77
v_perm_b32 v67, v71, v70, s77
ds_read_u16 v72, v51 offset:0
ds_read_u16 v73, v51 offset:256
ds_read_u16 v74, v51 offset:512
ds_read_u16 v75, v51 offset:768
ds_read_u16 v76, v51 offset:1024
ds_read_u16 v77, v51 offset:1280
ds_read_u16 v78, v51 offset:1536
ds_read_u16 v79, v51 offset:1792
s_waitcnt lgkmcnt(0)
v_perm_b32 v72, v73, v72, s77
v_perm_b32 v73, v75, v74, s77
v_perm_b32 v74, v77, v76, s77
v_perm_b32 v75, v79, v78, s77
ds_read_u16 v80, v50 offset:4096
ds_read_u16 v81, v50 offset:4352
ds_read_u16 v82, v50 offset:4608
ds_read_u16 v83, v50 offset:4864
ds_read_u16 v84, v50 offset:5120
ds_read_u16 v85, v50 offset:5376
ds_read_u16 v86, v50 offset:5632
ds_read_u16 v87, v50 offset:5888
s_waitcnt lgkmcnt(0)
v_perm_b32 v80, v81, v80, s77
v_perm_b32 v81, v83, v82, s77
v_perm_b32 v82, v85, v84, s77
v_perm_b32 v83, v87, v86, s77
ds_read_u16 v88, v51 offset:4096
ds_read_u16 v89, v51 offset:4352
ds_read_u16 v90, v51 offset:4608
ds_read_u16 v91, v51 offset:4864
ds_read_u16 v92, v51 offset:5120
ds_read_u16 v93, v51 offset:5376
ds_read_u16 v94, v51 offset:5632
ds_read_u16 v95, v51 offset:5888
s_waitcnt lgkmcnt(0)
v_perm_b32 v88, v89, v88, s77
v_perm_b32 v89, v91, v90, s77
v_perm_b32 v90, v93, v92, s77
v_perm_b32 v91, v95, v94, s77
buffer_store_dwordx4 v[64:67], v14, s[16:19], s74 offen offset:0 sc0 sc1
buffer_store_dwordx4 v[72:75], v14, s[16:19], s74 offen offset:1024 sc0 sc1
buffer_store_dwordx4 v[80:83], v14, s[16:19], s74 offen offset:2048 sc0 sc1
buffer_store_dwordx4 v[88:91], v14, s[16:19], s74 offen offset:3072 sc0 sc1
s_waitcnt vmcnt(4)
s_branch L_spf
L_w2:
ds_read_u16 v64, v50 offset:0
ds_read_u16 v65, v50 offset:256
ds_read_u16 v66, v50 offset:512
ds_read_u16 v67, v50 offset:768
ds_read_u16 v68, v50 offset:2048
ds_read_u16 v69, v50 offset:2304
ds_read_u16 v70, v50 offset:2560
ds_read_u16 v71, v50 offset:2816
s_waitcnt lgkmcnt(0)
v_perm_b32 v64, v65, v64, s77
v_perm_b32 v65, v67, v66, s77
v_perm_b32 v66, v69, v68, s77
v_perm_b32 v67, v71, v70, s77
ds_read_u16 v72, v51 offset:0
ds_read_u16 v73, v51 offset:256
ds_read_u16 v74, v51 offset:512
ds_read_u16 v75, v51 offset:768
ds_read_u16 v76, v51 offset:2048
ds_read_u16 v77, v51 offset:2304
ds_read_u16 v78, v51 offset:2560
ds_read_u16 v79, v51 offset:2816
s_waitcnt lgkmcnt(0)
v_perm_b32 v72, v73, v72, s77
v_perm_b32 v73, v75, v74, s77
v_perm_b32 v74, v77, v76, s77
v_perm_b32 v75, v79, v78, s77
ds_read_u16 v80, v50 offset:4096
ds_read_u16 v81, v50 offset:4352
ds_read_u16 v82, v50 offset:4608
ds_read_u16 v83, v50 offset:4864
ds_read_u16 v84, v50 offset:6144
ds_read_u16 v85, v50 offset:6400
ds_read_u16 v86, v50 offset:6656
ds_read_u16 v87, v50 offset:6912
s_waitcnt lgkmcnt(0)
v_perm_b32 v80, v81, v80, s77
v_perm_b32 v81, v83, v82, s77
v_perm_b32 v82, v85, v84, s77
v_perm_b32 v83, v87, v86, s77
ds_read_u16 v88, v51 offset:4096
ds_read_u16 v89, v51 offset:4352
ds_read_u16 v90, v51 offset:4608
ds_read_u16 v91, v51 offset:4864
ds_read_u16 v92, v51 offset:6144
ds_read_u16 v93, v51 offset:6400
ds_read_u16 v94, v51 offset:6656
ds_read_u16 v95, v51 offset:6912
s_waitcnt lgkmcnt(0)
v_perm_b32 v88, v89, v88, s77
v_perm_b32 v89, v91, v90, s77
v_perm_b32 v90, v93, v92, s77
v_perm_b32 v91, v95, v94, s77
s_lshr_b32 s72, s3, 1
s_xor_b32 s72, s72, s3
s_and_b32 s74, s3, 1
s_bitcmp1_b32 s72, 1
s_cbranch_scc1 L_w2b
s_lshl_b32 s74, s74, 13
s_add_u32 s74, s74, s73
s_add_u32 s74, s74, 27852800
s_add_u32 s72, s74, 4096
v_lshlrev_b32 v22, 2, v197
v_lshl_add_u32 v22, v47, 10, v22
buffer_store_dword v64, v22, s[16:19], s74 offen offset:0 sc0 sc1
buffer_store_dword v65, v22, s[16:19], s74 offen offset:256 sc0 sc1
buffer_store_dword v66, v22, s[16:19], s74 offen offset:512 sc0 sc1
buffer_store_dword v67, v22, s[16:19], s74 offen offset:768 sc0 sc1
buffer_store_dword v72, v22, s[16:19], s74 offen offset:2048 sc0 sc1
buffer_store_dword v73, v22, s[16:19], s74 offen offset:2304 sc0 sc1
buffer_store_dword v74, v22, s[16:19], s74 offen offset:2560 sc0 sc1
buffer_store_dword v75, v22, s[16:19], s74 offen offset:2816 sc0 sc1
buffer_store_dword v80, v22, s[16:19], s72 offen offset:0 sc0 sc1
buffer_store_dword v81, v22, s[16:19], s72 offen offset:256 sc0 sc1
buffer_store_dword v82, v22, s[16:19], s72 offen offset:512 sc0 sc1
buffer_store_dword v83, v22, s[16:19], s72 offen offset:768 sc0 sc1
buffer_store_dword v88, v22, s[16:19], s72 offen offset:2048 sc0 sc1
buffer_store_dword v89, v22, s[16:19], s72 offen offset:2304 sc0 sc1
buffer_store_dword v90, v22, s[16:19], s72 offen offset:2560 sc0 sc1
buffer_store_dword v91, v22, s[16:19], s72 offen offset:2816 sc0 sc1
s_waitcnt vmcnt(16)
s_branch L_spf
L_w2b:
s_lshl_b32 s74, s74, 12
s_lshl_b32 s73, s73, 6
s_add_u32 s74, s74, s73
s_add_u32 s74, s74, 27869184
buffer_store_dwordx4 v[64:67], v14, s[16:19], s74 offen offset:0 sc0 sc1
buffer_store_dwordx4 v[72:75], v14, s[16:19], s74 offen offset:1024 sc0 sc1
buffer_store_dwordx4 v[80:83], v14, s[16:19], s74 offen offset:2048 sc0 sc1
buffer_store_dwordx4 v[88:91], v14, s[16:19], s74 offen offset:3072 sc0 sc1
s_waitcnt vmcnt(4)
s_branch L_spf
L_sm2:
s_and_b32 s72, s3, 3
s_cmp_ge_u32 s3, 4
s_cbranch_scc1 L_wdi
v_lshlrev_b32 v16, 16, v16
v_mul_f32 v16, s64, v16
v_lshlrev_b32 v17, 16, v17
v_mul_f32 v17, s64, v17
v_lshlrev_b32 v18, 16, v18
v_mul_f32 v18, s64, v18
v_lshlrev_b32 v19, 16, v19
v_mul_f32 v19, s64, v19
v_lshlrev_b32 v20, 16, v20
v_mul_f32 v20, s64, v20
v_lshlrev_b32 v21, 16, v21
v_mul_f32 v21, s64, v21
v_lshlrev_b32 v22, 16, v22
v_mul_f32 v22, s64, v22
v_lshlrev_b32 v23, 16, v23
v_mul_f32 v23, s64, v23
v_cvt_pk_bf16_f32 v16, v16, v17
v_cvt_pk_bf16_f32 v17, v18, v19
v_cvt_pk_bf16_f32 v18, v20, v21
v_cvt_pk_bf16_f32 v19, v22, v23
s_lshl_b32 s72, s72, 10
s_add_u32 s72, s72, 27885568
buffer_store_dwordx4 v[16:19], v14, s[16:19], s72 offen sc0 sc1
s_mov_b32 s73, 27890688
buffer_store_dword v24, v1, s[16:19], s73 offen sc0 sc1
s_waitcnt vmcnt(2)
s_branch L_spf
L_wdi:
v_cmp_gt_u32 vcc, 32, v2
s_lshl_b32 s72, s72, 8
s_add_u32 s72, s72, 27889664
v_lshlrev_b32 v25, 16, v25
v_mul_f32 v25, s64, v25
v_cvt_pk_bf16_f32 v25, 0, v25
v_cndmask_b32 v25, 0, v25, vcc
buffer_store_dword v25, v1, s[16:19], s72 offen sc0 sc1
s_waitcnt vmcnt(1)
s_branch L_spf
L_sp0:
s_waitcnt vmcnt(0)
L_spf:
s_add_u32 m0, s57, 51840
s_add_u32 s82, s57, 0
buffer_load_dwordx4 v99, s[8:11], s82 offen lds
s_add_u32 m0, s57, 60032
s_add_u32 s82, s57, 8192
buffer_load_dwordx4 v99, s[8:11], s82 offen lds
s_add_u32 m0, s57, 68224
s_add_u32 s82, s57, 16384
buffer_load_dwordx4 v99, s[8:11], s82 offen lds
s_add_u32 m0, s57, 76416
s_add_u32 s82, s57, 24576
buffer_load_dwordx4 v99, s[8:11], s82 offen lds
s_mov_b32 s8, s32
s_mov_b32 s9, s33
s_mov_b32 s10, 6400000
s_sub_u32 s72, s2, 251
s_lshl_b32 s73, s3, 5
s_add_u32 s73, s73, s72
s_lshl_b32 s73, s73, 3
s_add_u32 s73, s73, 27983872
v_cmp_ne_u32 vcc, 0, v172
s_cbranch_vccnz L_spg
L_spn:
s_add_u32 s30, s30, 1
s_cmp_gt_u32 s30, 2000000
s_cbranch_scc1 L_end
buffer_load_dwordx2 v[172:173], off, s[12:15], 0 sc1
s_waitcnt vmcnt(0)
v_cmp_eq_u32 vcc, 0, v172
s_cbranch_vccnz L_spn
L_spg:
ds_write_b64 v61, v[172:173] offset:41200
s_waitcnt lgkmcnt(0)
s_barrier
s_branch L_gemm
L_end:
s_endpgm
.section .rodata,"a"
.p2align 6
.amdhsa_kernel gather_scatter__cheap_equivariant_egnn__graph_kernel
  .amdhsa_next_free_vgpr 256
  .amdhsa_next_free_sgpr 102
  .amdhsa_accum_offset 256
  .amdhsa_group_segment_fixed_size 0
  .amdhsa_kernarg_size 88
  .amdhsa_user_sgpr_count 2
  .amdhsa_user_sgpr_kernarg_segment_ptr 1
  .amdhsa_system_sgpr_workgroup_id_x 1
.end_amdhsa_kernel
```
